```python
import torch

def _softmax(x, axis=-1):
    return torch.softmax(x, dim=axis)
def _gelu(x):
    return torch.nn.functional.gelu(x, approximate="tanh")
def _silu(x):
    return torch.nn.functional.silu(x)
def _sigmoid(x):
    return torch.sigmoid(x)
def _layernorm(x, axis=-1, eps=1e-5):
    m = x.mean(dim=axis, keepdim=True)
    v = x.var(dim=axis, keepdim=True, unbiased=False)
    return (x - m) / torch.sqrt(v + eps)
def _scatter_add(tgt, idx, src, axis=0):
    return tgt.clone().index_add_(axis, idx, src)
def _segment_sum(src, seg, n):
    out = torch.zeros((n,) + src.shape[1:], dtype=src.dtype)
    return out.index_add_(0, seg, src)
def _pad(x, pw):
    flat = tuple(v for pair in reversed(pw) for v in pair)
    return torch.nn.functional.pad(x, flat)

kernel_name = 'gated_mix__grouped_kv_mqa__mixer_token_mlp__prompt'

def setup_inputs():

    _w = (lambda a: (lambda t: t.to(torch.bfloat16) if t.is_floating_point() else t)(torch.as_tensor(a)))
    def _A_setup():
        B, S, D, H = 1, 2048, 640, 32
        Dh = D // H
        return {
            "x": _w((lambda *s: torch.randn(*s, dtype=torch.bfloat16) * 0.05)(B, S, D)),
            "wq": _w((lambda *s: torch.randn(*s, dtype=torch.bfloat16) * 0.8)(D, H * Dh)),
            "wk": _w((lambda *s: torch.randn(*s, dtype=torch.bfloat16) * 0.8)(D, Dh)),
            "wv": _w((lambda *s: torch.randn(*s, dtype=torch.bfloat16) * 0.05)(D, Dh)),
            "wo": _w((lambda *s: torch.randn(*s, dtype=torch.bfloat16) * 0.05)(H * Dh, D)),
        }
    _A_in = _A_setup()

    def _B_setup():
        B, S, D, F = 1, 2048, 640, 1536
        return {
            "x": _w((lambda *s: torch.randn(*s, dtype=torch.bfloat16) * 0.05)(B, S, D)),
            "w1": _w((lambda *s: torch.randn(*s, dtype=torch.bfloat16) * 0.2)(S, F) * (S ** -0.5)),
            "b1": _w((lambda *s: torch.randn(*s, dtype=torch.bfloat16) * 3.2)(F) * 0.02),
            "w2": _w((lambda *s: torch.randn(*s, dtype=torch.bfloat16) * 0.05)(F, S) * (F ** -0.5)),
            "b2": _w((lambda *s: torch.randn(*s, dtype=torch.bfloat16) * 0.1)(S) * 0.02),
        }
    _B_in = _B_setup()

    return {
        "A_x": _A_in["x"],
        "A_wq": _A_in["wq"],
        "A_wk": _A_in["wk"],
        "A_wv": _A_in["wv"],
        "A_wo": _A_in["wo"],
        "B_x": _B_in["x"],
        "B_w1": _B_in["w1"],
        "B_b1": _B_in["b1"],
        "B_w2": _B_in["w2"],
        "B_b2": _B_in["b2"],
        "gate_w": _w((lambda *s: torch.randn(*s, dtype=torch.bfloat16) * 0.05)(640) * 16.0),
    }

def reference(A_x, A_wq, A_wk, A_wv, A_wo, B_x, B_w1, B_b1, B_w2, B_b2, gate_w):
    def _A_ref(x, wq, wk, wv, wo):
        B, S, D = x.shape
        H = 32
        Dh = D // H
        q = (lambda x, *d: x.permute(*d))((x @ wq).reshape(B, S, H, Dh), 0, 2, 1, 3)
        k = x @ wk
        v = x @ wv
        scores = torch.einsum("bhqd,bkd->bhqk", q, k) * (Dh ** -0.5)
        p = _softmax(scores, axis=-1)
        o = torch.einsum("bhqk,bkd->bhqd", p, v)
        return (lambda x, *d: x.permute(*d))(o, 0, 2, 1, 3).reshape(B, S, H * Dh) @ wo

    def _B_ref(x, w1, b1, w2, b2):
        B, S, D = x.shape
        h = _layernorm(x, axis=-1)
        u = torch.einsum("bsd,sf->bdf", h, w1) + b1
        u = _gelu(u)
        y = torch.einsum("bdf,fs->bds", u, w2) + b2
        return (lambda x, *d: x.permute(*d))(y, 0, 2, 1)

    x = A_x
    g = _sigmoid((x * gate_w).sum(-1, keepdims=True))
    a = _A_ref(x, A_wq, A_wk, A_wv, A_wo)
    b = _B_ref(x, B_w1, B_b1, B_w2, B_b2)
    return g * a + (1 - g) * b
```

```asm
; @launch kernel=k1_kernel grid=(576,1,1) block=(256,1,1) lds=53248
; @launch kernel=k2_kernel grid=(256,1,1) block=(768,1,1) lds=151552
; @launch kernel=k3_kernel grid=(256,1,1) block=(512,1,1) lds=147520
.amdgcn_target "amdgcn-amd-amdhsa--gfx950"
.text
.globl k1_kernel
.p2align 8
.type k1_kernel,@function
k1_kernel:
    s_cmp_ge_u32 s2, 576
    s_cbranch_scc1 K1_END
    v_lshrrev_b32 v1, 6, v0
    v_and_b32 v2, 63, v0
    s_nop 0
    v_readfirstlane_b32 s3, v1
    s_load_dwordx2 s[4:5], s[0:1], 0
    s_load_dwordx2 s[6:7], s[0:1], 8
    s_load_dwordx2 s[20:21], s[0:1], 104
    s_load_dwordx2 s[22:23], s[0:1], 16
    s_load_dwordx2 s[24:25], s[0:1], 24
    s_load_dwordx2 s[26:27], s[0:1], 80
    s_waitcnt lgkmcnt(0)
    s_mov_b32 s8, s4
    s_and_b32 s9, s5, 0xffff
    s_mov_b32 s10, 2621440
    s_mov_b32 s11, 0x00020000
    s_cmp_ge_u32 s2, 320
    s_cbranch_scc1 K1_ROWS
    s_mov_b32 s12, s6
    s_and_b32 s13, s7, 0xffff
    s_mov_b32 s14, 819200
    s_mov_b32 s15, 0x00020000
    s_add_u32 s16, s20, 0
    s_addc_u32 s17, s21, 0
    s_and_b32 s17, s17, 0xffff
    s_mov_b32 s18, 2621440
    s_mov_b32 s19, 0x00020000
    s_and_b32 s60, s2, 7
    s_lshr_b32 s61, s2, 3
    s_mul_hi_u32 s28, s61, 0x33333334
    s_mul_i32 s29, s28, 5
    s_sub_u32 s29, s61, s29
    s_and_b32 s34, s60, 3
    s_lshl_b32 s34, s34, 3
    s_add_u32 s28, s28, s34
    s_lshr_b32 s34, s60, 2
    s_mul_i32 s34, s34, 5
    s_add_u32 s29, s29, s34
    s_mov_b32 s30, 1280
    s_mul_i32 s31, s3, 20480
    s_lshl_b32 s34, s29, 7
    s_add_u32 s31, s31, s34
    s_lshl_b32 s32, s28, 6
    s_mul_i32 s34, s3, 16
    s_add_u32 s32, s32, s34
    s_mul_i32 s32, s32, 1280
    s_lshl_b32 s33, s3, 11
    s_and_b32 s35, s3, 1
    s_lshr_b32 s36, s3, 1
    s_mov_b32 s37, s35
    s_mov_b32 s38, s36
    v_lshrrev_b32 v10, 3, v2
    v_mul_lo_u32 v10, v10, s30
    v_lshrrev_b32 v11, 4, v2
    v_and_b32 v11, 1, v11
    v_lshlrev_b32 v11, 2, v11
    v_and_b32 v3, 7, v2
    v_xor_b32 v3, v3, v11
    v_lshlrev_b32 v3, 4, v3
    v_add_u32 v3, v3, v10
    v_lshrrev_b32 v10, 3, v2
    v_mul_lo_u32 v10, v10, s30
    v_lshrrev_b32 v11, 4, v2
    v_add_u32 v11, 0, v11
    v_and_b32 v4, 7, v2
    v_xor_b32 v4, v4, v11
    v_lshlrev_b32 v4, 4, v4
    v_add_u32 v4, v4, v10
    v_lshrrev_b32 v10, 3, v2
    v_mul_lo_u32 v10, v10, s30
    v_lshrrev_b32 v11, 4, v2
    v_add_u32 v11, 4, v11
    v_and_b32 v5, 7, v2
    v_xor_b32 v5, v5, v11
    v_lshlrev_b32 v5, 4, v5
    v_add_u32 v5, v5, v10
    v_and_b32 v10, 3, v2
    v_lshlrev_b32 v10, 3, v10
    v_lshrrev_b32 v11, 4, v2
    v_and_b32 v11, 1, v11
    v_lshlrev_b32 v11, 5, v11
    v_add_u32 v10, v10, v11
    s_lshl_b32 s37, s37, 6
    v_add_u32 v10, s37, v10
    v_lshrrev_b32 v11, 3, v2
    v_and_b32 v11, 1, v11
    v_lshlrev_b32 v11, 6, v11
    v_xor_b32 v10, v10, v11
    v_lshrrev_b32 v11, 2, v2
    v_and_b32 v11, 3, v11
    v_lshlrev_b32 v11, 7, v11
    v_add_u32 v10, v10, v11
    v_lshrrev_b32 v11, 5, v2
    v_lshlrev_b32 v11, 10, v11
    v_add_u32 v6, v10, v11
    v_and_b32 v10, 31, v2
    s_lshl_b32 s38, s38, 5
    v_add_u32 v10, s38, v10
    v_lshrrev_b32 v11, 1, v10
    v_and_b32 v11, 7, v11
    v_lshrrev_b32 v7, 5, v2
    v_xor_b32 v7, v7, v11
    v_lshlrev_b32 v7, 4, v7
    v_lshlrev_b32 v10, 7, v10
    v_add_u32 v7, v7, v10
    s_add_u32 m0, s33, 0
    s_add_u32 s34, s31, 0
    buffer_load_dwordx4 v3, s[12:15], s34 offen lds
    s_add_u32 m0, s33, 1024
    s_add_u32 s34, s31, 10240
    buffer_load_dwordx4 v3, s[12:15], s34 offen lds
    s_add_u32 m0, s33, 8192
    s_add_u32 s34, s32, 0
    buffer_load_dwordx4 v4, s[8:11], s34 offen lds
    s_add_u32 m0, s33, 9216
    s_add_u32 s34, s32, 10240
    buffer_load_dwordx4 v5, s[8:11], s34 offen lds
    s_add_u32 m0, s33, 16384
    s_add_u32 s34, s31, 81920
    buffer_load_dwordx4 v3, s[12:15], s34 offen lds
    s_add_u32 m0, s33, 17408
    s_add_u32 s34, s31, 92160
    buffer_load_dwordx4 v3, s[12:15], s34 offen lds
    s_add_u32 m0, s33, 24576
    s_add_u32 s34, s32, 128
    buffer_load_dwordx4 v4, s[8:11], s34 offen lds
    s_add_u32 m0, s33, 25600
    s_add_u32 s34, s32, 10368
    buffer_load_dwordx4 v5, s[8:11], s34 offen lds
    s_waitcnt vmcnt(4)
    s_barrier
    s_add_u32 m0, s33, 32768
    s_add_u32 s34, s31, 163840
    buffer_load_dwordx4 v3, s[12:15], s34 offen lds
    s_add_u32 m0, s33, 33792
    s_add_u32 s34, s31, 174080
    buffer_load_dwordx4 v3, s[12:15], s34 offen lds
    s_add_u32 m0, s33, 40960
    s_add_u32 s34, s32, 256
    buffer_load_dwordx4 v4, s[8:11], s34 offen lds
    s_add_u32 m0, s33, 41984
    s_add_u32 s34, s32, 10496
    buffer_load_dwordx4 v5, s[8:11], s34 offen lds
    ds_read_b64_tr_b16 v[32:33], v6 offset:0
    ds_read_b64_tr_b16 v[34:35], v6 offset:512
    ds_read_b128 v[44:47], v7 offset:8192
    ds_read_b64_tr_b16 v[36:37], v6 offset:2048
    ds_read_b64_tr_b16 v[38:39], v6 offset:2560
    v_xor_b32 v13, 32, v7
    ds_read_b128 v[48:51], v13 offset:8192
    ds_read_b64_tr_b16 v[40:41], v6 offset:4096
    ds_read_b64_tr_b16 v[42:43], v6 offset:4608
    v_xor_b32 v13, 64, v7
    ds_read_b128 v[52:55], v13 offset:8192
    s_waitcnt lgkmcnt(6)
    v_mfma_f32_32x32x16_bf16 v[16:31], v[32:35], v[44:47], 0
    ds_read_b64_tr_b16 v[32:33], v6 offset:6144
    ds_read_b64_tr_b16 v[34:35], v6 offset:6656
    v_xor_b32 v13, 96, v7
    ds_read_b128 v[44:47], v13 offset:8192
    s_waitcnt lgkmcnt(6)
    v_mfma_f32_32x32x16_bf16 v[16:31], v[36:39], v[48:51], v[16:31]
    s_waitcnt lgkmcnt(3)
    v_mfma_f32_32x32x16_bf16 v[16:31], v[40:43], v[52:55], v[16:31]
    s_waitcnt lgkmcnt(0)
    v_mfma_f32_32x32x16_bf16 v[16:31], v[32:35], v[44:47], v[16:31]
    s_waitcnt vmcnt(4)
    s_barrier
    s_add_u32 m0, s33, 0
    s_add_u32 s34, s31, 245760
    buffer_load_dwordx4 v3, s[12:15], s34 offen lds
    s_add_u32 m0, s33, 1024
    s_add_u32 s34, s31, 256000
    buffer_load_dwordx4 v3, s[12:15], s34 offen lds
    s_add_u32 m0, s33, 8192
    s_add_u32 s34, s32, 384
    buffer_load_dwordx4 v4, s[8:11], s34 offen lds
    s_add_u32 m0, s33, 9216
    s_add_u32 s34, s32, 10624
    buffer_load_dwordx4 v5, s[8:11], s34 offen lds
    ds_read_b64_tr_b16 v[32:33], v6 offset:16384
    ds_read_b64_tr_b16 v[34:35], v6 offset:16896
    ds_read_b128 v[44:47], v7 offset:24576
    ds_read_b64_tr_b16 v[36:37], v6 offset:18432
    ds_read_b64_tr_b16 v[38:39], v6 offset:18944
    v_xor_b32 v13, 32, v7
    ds_read_b128 v[48:51], v13 offset:24576
    ds_read_b64_tr_b16 v[40:41], v6 offset:20480
    ds_read_b64_tr_b16 v[42:43], v6 offset:20992
    v_xor_b32 v13, 64, v7
    ds_read_b128 v[52:55], v13 offset:24576
    s_waitcnt lgkmcnt(6)
    v_mfma_f32_32x32x16_bf16 v[16:31], v[32:35], v[44:47], v[16:31]
    ds_read_b64_tr_b16 v[32:33], v6 offset:22528
    ds_read_b64_tr_b16 v[34:35], v6 offset:23040
    v_xor_b32 v13, 96, v7
    ds_read_b128 v[44:47], v13 offset:24576
    s_waitcnt lgkmcnt(6)
    v_mfma_f32_32x32x16_bf16 v[16:31], v[36:39], v[48:51], v[16:31]
    s_waitcnt lgkmcnt(3)
    v_mfma_f32_32x32x16_bf16 v[16:31], v[40:43], v[52:55], v[16:31]
    s_waitcnt lgkmcnt(0)
    v_mfma_f32_32x32x16_bf16 v[16:31], v[32:35], v[44:47], v[16:31]
    s_waitcnt vmcnt(4)
    s_barrier
    s_add_u32 m0, s33, 16384
    s_add_u32 s34, s31, 327680
    buffer_load_dwordx4 v3, s[12:15], s34 offen lds
    s_add_u32 m0, s33, 17408
    s_add_u32 s34, s31, 337920
    buffer_load_dwordx4 v3, s[12:15], s34 offen lds
    s_add_u32 m0, s33, 24576
    s_add_u32 s34, s32, 512
    buffer_load_dwordx4 v4, s[8:11], s34 offen lds
    s_add_u32 m0, s33, 25600
    s_add_u32 s34, s32, 10752
    buffer_load_dwordx4 v5, s[8:11], s34 offen lds
    ds_read_b64_tr_b16 v[32:33], v6 offset:32768
    ds_read_b64_tr_b16 v[34:35], v6 offset:33280
    ds_read_b128 v[44:47], v7 offset:40960
    ds_read_b64_tr_b16 v[36:37], v6 offset:34816
    ds_read_b64_tr_b16 v[38:39], v6 offset:35328
    v_xor_b32 v13, 32, v7
    ds_read_b128 v[48:51], v13 offset:40960
    ds_read_b64_tr_b16 v[40:41], v6 offset:36864
    ds_read_b64_tr_b16 v[42:43], v6 offset:37376
    v_xor_b32 v13, 64, v7
    ds_read_b128 v[52:55], v13 offset:40960
    s_waitcnt lgkmcnt(6)
    v_mfma_f32_32x32x16_bf16 v[16:31], v[32:35], v[44:47], v[16:31]
    ds_read_b64_tr_b16 v[32:33], v6 offset:38912
    ds_read_b64_tr_b16 v[34:35], v6 offset:39424
    v_xor_b32 v13, 96, v7
    ds_read_b128 v[44:47], v13 offset:40960
    s_waitcnt lgkmcnt(6)
    v_mfma_f32_32x32x16_bf16 v[16:31], v[36:39], v[48:51], v[16:31]
    s_waitcnt lgkmcnt(3)
    v_mfma_f32_32x32x16_bf16 v[16:31], v[40:43], v[52:55], v[16:31]
    s_waitcnt lgkmcnt(0)
    v_mfma_f32_32x32x16_bf16 v[16:31], v[32:35], v[44:47], v[16:31]
    s_waitcnt vmcnt(4)
    s_barrier
    s_add_u32 m0, s33, 32768
    s_add_u32 s34, s31, 409600
    buffer_load_dwordx4 v3, s[12:15], s34 offen lds
    s_add_u32 m0, s33, 33792
    s_add_u32 s34, s31, 419840
    buffer_load_dwordx4 v3, s[12:15], s34 offen lds
    s_add_u32 m0, s33, 40960
    s_add_u32 s34, s32, 640
    buffer_load_dwordx4 v4, s[8:11], s34 offen lds
    s_add_u32 m0, s33, 41984
    s_add_u32 s34, s32, 10880
    buffer_load_dwordx4 v5, s[8:11], s34 offen lds
    ds_read_b64_tr_b16 v[32:33], v6 offset:0
    ds_read_b64_tr_b16 v[34:35], v6 offset:512
    ds_read_b128 v[44:47], v7 offset:8192
    ds_read_b64_tr_b16 v[36:37], v6 offset:2048
    ds_read_b64_tr_b16 v[38:39], v6 offset:2560
    v_xor_b32 v13, 32, v7
    ds_read_b128 v[48:51], v13 offset:8192
    ds_read_b64_tr_b16 v[40:41], v6 offset:4096
    ds_read_b64_tr_b16 v[42:43], v6 offset:4608
    v_xor_b32 v13, 64, v7
    ds_read_b128 v[52:55], v13 offset:8192
    s_waitcnt lgkmcnt(6)
    v_mfma_f32_32x32x16_bf16 v[16:31], v[32:35], v[44:47], v[16:31]
    ds_read_b64_tr_b16 v[32:33], v6 offset:6144
    ds_read_b64_tr_b16 v[34:35], v6 offset:6656
    v_xor_b32 v13, 96, v7
    ds_read_b128 v[44:47], v13 offset:8192
    s_waitcnt lgkmcnt(6)
    v_mfma_f32_32x32x16_bf16 v[16:31], v[36:39], v[48:51], v[16:31]
    s_waitcnt lgkmcnt(3)
    v_mfma_f32_32x32x16_bf16 v[16:31], v[40:43], v[52:55], v[16:31]
    s_waitcnt lgkmcnt(0)
    v_mfma_f32_32x32x16_bf16 v[16:31], v[32:35], v[44:47], v[16:31]
    s_waitcnt vmcnt(4)
    s_barrier
    s_add_u32 m0, s33, 0
    s_add_u32 s34, s31, 491520
    buffer_load_dwordx4 v3, s[12:15], s34 offen lds
    s_add_u32 m0, s33, 1024
    s_add_u32 s34, s31, 501760
    buffer_load_dwordx4 v3, s[12:15], s34 offen lds
    s_add_u32 m0, s33, 8192
    s_add_u32 s34, s32, 768
    buffer_load_dwordx4 v4, s[8:11], s34 offen lds
    s_add_u32 m0, s33, 9216
    s_add_u32 s34, s32, 11008
    buffer_load_dwordx4 v5, s[8:11], s34 offen lds
    ds_read_b64_tr_b16 v[32:33], v6 offset:16384
    ds_read_b64_tr_b16 v[34:35], v6 offset:16896
    ds_read_b128 v[44:47], v7 offset:24576
    ds_read_b64_tr_b16 v[36:37], v6 offset:18432
    ds_read_b64_tr_b16 v[38:39], v6 offset:18944
    v_xor_b32 v13, 32, v7
    ds_read_b128 v[48:51], v13 offset:24576
    ds_read_b64_tr_b16 v[40:41], v6 offset:20480
    ds_read_b64_tr_b16 v[42:43], v6 offset:20992
    v_xor_b32 v13, 64, v7
    ds_read_b128 v[52:55], v13 offset:24576
    s_waitcnt lgkmcnt(6)
    v_mfma_f32_32x32x16_bf16 v[16:31], v[32:35], v[44:47], v[16:31]
    ds_read_b64_tr_b16 v[32:33], v6 offset:22528
    ds_read_b64_tr_b16 v[34:35], v6 offset:23040
    v_xor_b32 v13, 96, v7
    ds_read_b128 v[44:47], v13 offset:24576
    s_waitcnt lgkmcnt(6)
    v_mfma_f32_32x32x16_bf16 v[16:31], v[36:39], v[48:51], v[16:31]
    s_waitcnt lgkmcnt(3)
    v_mfma_f32_32x32x16_bf16 v[16:31], v[40:43], v[52:55], v[16:31]
    s_waitcnt lgkmcnt(0)
    v_mfma_f32_32x32x16_bf16 v[16:31], v[32:35], v[44:47], v[16:31]
    s_waitcnt vmcnt(4)
    s_barrier
    s_add_u32 m0, s33, 16384
    s_add_u32 s34, s31, 573440
    buffer_load_dwordx4 v3, s[12:15], s34 offen lds
    s_add_u32 m0, s33, 17408
    s_add_u32 s34, s31, 583680
    buffer_load_dwordx4 v3, s[12:15], s34 offen lds
    s_add_u32 m0, s33, 24576
    s_add_u32 s34, s32, 896
    buffer_load_dwordx4 v4, s[8:11], s34 offen lds
    s_add_u32 m0, s33, 25600
    s_add_u32 s34, s32, 11136
    buffer_load_dwordx4 v5, s[8:11], s34 offen lds
    ds_read_b64_tr_b16 v[32:33], v6 offset:32768
    ds_read_b64_tr_b16 v[34:35], v6 offset:33280
    ds_read_b128 v[44:47], v7 offset:40960
    ds_read_b64_tr_b16 v[36:37], v6 offset:34816
    ds_read_b64_tr_b16 v[38:39], v6 offset:35328
    v_xor_b32 v13, 32, v7
    ds_read_b128 v[48:51], v13 offset:40960
    ds_read_b64_tr_b16 v[40:41], v6 offset:36864
    ds_read_b64_tr_b16 v[42:43], v6 offset:37376
    v_xor_b32 v13, 64, v7
    ds_read_b128 v[52:55], v13 offset:40960
    s_waitcnt lgkmcnt(6)
    v_mfma_f32_32x32x16_bf16 v[16:31], v[32:35], v[44:47], v[16:31]
    ds_read_b64_tr_b16 v[32:33], v6 offset:38912
    ds_read_b64_tr_b16 v[34:35], v6 offset:39424
    v_xor_b32 v13, 96, v7
    ds_read_b128 v[44:47], v13 offset:40960
    s_waitcnt lgkmcnt(6)
    v_mfma_f32_32x32x16_bf16 v[16:31], v[36:39], v[48:51], v[16:31]
    s_waitcnt lgkmcnt(3)
    v_mfma_f32_32x32x16_bf16 v[16:31], v[40:43], v[52:55], v[16:31]
    s_waitcnt lgkmcnt(0)
    v_mfma_f32_32x32x16_bf16 v[16:31], v[32:35], v[44:47], v[16:31]
    s_waitcnt vmcnt(4)
    s_barrier
    s_add_u32 m0, s33, 32768
    s_add_u32 s34, s31, 655360
    buffer_load_dwordx4 v3, s[12:15], s34 offen lds
    s_add_u32 m0, s33, 33792
    s_add_u32 s34, s31, 665600
    buffer_load_dwordx4 v3, s[12:15], s34 offen lds
    s_add_u32 m0, s33, 40960
    s_add_u32 s34, s32, 1024
    buffer_load_dwordx4 v4, s[8:11], s34 offen lds
    s_add_u32 m0, s33, 41984
    s_add_u32 s34, s32, 11264
    buffer_load_dwordx4 v5, s[8:11], s34 offen lds
    ds_read_b64_tr_b16 v[32:33], v6 offset:0
    ds_read_b64_tr_b16 v[34:35], v6 offset:512
    ds_read_b128 v[44:47], v7 offset:8192
    ds_read_b64_tr_b16 v[36:37], v6 offset:2048
    ds_read_b64_tr_b16 v[38:39], v6 offset:2560
    v_xor_b32 v13, 32, v7
    ds_read_b128 v[48:51], v13 offset:8192
    ds_read_b64_tr_b16 v[40:41], v6 offset:4096
    ds_read_b64_tr_b16 v[42:43], v6 offset:4608
    v_xor_b32 v13, 64, v7
    ds_read_b128 v[52:55], v13 offset:8192
    s_waitcnt lgkmcnt(6)
    v_mfma_f32_32x32x16_bf16 v[16:31], v[32:35], v[44:47], v[16:31]
    ds_read_b64_tr_b16 v[32:33], v6 offset:6144
    ds_read_b64_tr_b16 v[34:35], v6 offset:6656
    v_xor_b32 v13, 96, v7
    ds_read_b128 v[44:47], v13 offset:8192
    s_waitcnt lgkmcnt(6)
    v_mfma_f32_32x32x16_bf16 v[16:31], v[36:39], v[48:51], v[16:31]
    s_waitcnt lgkmcnt(3)
    v_mfma_f32_32x32x16_bf16 v[16:31], v[40:43], v[52:55], v[16:31]
    s_waitcnt lgkmcnt(0)
    v_mfma_f32_32x32x16_bf16 v[16:31], v[32:35], v[44:47], v[16:31]
    s_waitcnt vmcnt(4)
    s_barrier
    s_add_u32 m0, s33, 0
    s_add_u32 s34, s31, 737280
    buffer_load_dwordx4 v3, s[12:15], s34 offen lds
    s_add_u32 m0, s33, 1024
    s_add_u32 s34, s31, 747520
    buffer_load_dwordx4 v3, s[12:15], s34 offen lds
    s_add_u32 m0, s33, 8192
    s_add_u32 s34, s32, 1152
    buffer_load_dwordx4 v4, s[8:11], s34 offen lds
    s_add_u32 m0, s33, 9216
    s_add_u32 s34, s32, 11392
    buffer_load_dwordx4 v5, s[8:11], s34 offen lds
    ds_read_b64_tr_b16 v[32:33], v6 offset:16384
    ds_read_b64_tr_b16 v[34:35], v6 offset:16896
    ds_read_b128 v[44:47], v7 offset:24576
    ds_read_b64_tr_b16 v[36:37], v6 offset:18432
    ds_read_b64_tr_b16 v[38:39], v6 offset:18944
    v_xor_b32 v13, 32, v7
    ds_read_b128 v[48:51], v13 offset:24576
    ds_read_b64_tr_b16 v[40:41], v6 offset:20480
    ds_read_b64_tr_b16 v[42:43], v6 offset:20992
    v_xor_b32 v13, 64, v7
    ds_read_b128 v[52:55], v13 offset:24576
    s_waitcnt lgkmcnt(6)
    v_mfma_f32_32x32x16_bf16 v[16:31], v[32:35], v[44:47], v[16:31]
    ds_read_b64_tr_b16 v[32:33], v6 offset:22528
    ds_read_b64_tr_b16 v[34:35], v6 offset:23040
    v_xor_b32 v13, 96, v7
    ds_read_b128 v[44:47], v13 offset:24576
    s_waitcnt lgkmcnt(6)
    v_mfma_f32_32x32x16_bf16 v[16:31], v[36:39], v[48:51], v[16:31]
    s_waitcnt lgkmcnt(3)
    v_mfma_f32_32x32x16_bf16 v[16:31], v[40:43], v[52:55], v[16:31]
    s_waitcnt lgkmcnt(0)
    v_mfma_f32_32x32x16_bf16 v[16:31], v[32:35], v[44:47], v[16:31]
    s_waitcnt vmcnt(4)
    s_barrier
    ds_read_b64_tr_b16 v[32:33], v6 offset:32768
    ds_read_b64_tr_b16 v[34:35], v6 offset:33280
    ds_read_b128 v[44:47], v7 offset:40960
    ds_read_b64_tr_b16 v[36:37], v6 offset:34816
    ds_read_b64_tr_b16 v[38:39], v6 offset:35328
    v_xor_b32 v13, 32, v7
    ds_read_b128 v[48:51], v13 offset:40960
    ds_read_b64_tr_b16 v[40:41], v6 offset:36864
    ds_read_b64_tr_b16 v[42:43], v6 offset:37376
    v_xor_b32 v13, 64, v7
    ds_read_b128 v[52:55], v13 offset:40960
    s_waitcnt lgkmcnt(6)
    v_mfma_f32_32x32x16_bf16 v[16:31], v[32:35], v[44:47], v[16:31]
    ds_read_b64_tr_b16 v[32:33], v6 offset:38912
    ds_read_b64_tr_b16 v[34:35], v6 offset:39424
    v_xor_b32 v13, 96, v7
    ds_read_b128 v[44:47], v13 offset:40960
    s_waitcnt lgkmcnt(6)
    v_mfma_f32_32x32x16_bf16 v[16:31], v[36:39], v[48:51], v[16:31]
    s_waitcnt lgkmcnt(3)
    v_mfma_f32_32x32x16_bf16 v[16:31], v[40:43], v[52:55], v[16:31]
    s_waitcnt lgkmcnt(0)
    v_mfma_f32_32x32x16_bf16 v[16:31], v[32:35], v[44:47], v[16:31]
    s_waitcnt vmcnt(0)
    s_barrier
    ds_read_b64_tr_b16 v[32:33], v6 offset:0
    ds_read_b64_tr_b16 v[34:35], v6 offset:512
    ds_read_b128 v[44:47], v7 offset:8192
    ds_read_b64_tr_b16 v[36:37], v6 offset:2048
    ds_read_b64_tr_b16 v[38:39], v6 offset:2560
    v_xor_b32 v13, 32, v7
    ds_read_b128 v[48:51], v13 offset:8192
    ds_read_b64_tr_b16 v[40:41], v6 offset:4096
    ds_read_b64_tr_b16 v[42:43], v6 offset:4608
    v_xor_b32 v13, 64, v7
    ds_read_b128 v[52:55], v13 offset:8192
    s_waitcnt lgkmcnt(6)
    v_mfma_f32_32x32x16_bf16 v[16:31], v[32:35], v[44:47], v[16:31]
    ds_read_b64_tr_b16 v[32:33], v6 offset:6144
    ds_read_b64_tr_b16 v[34:35], v6 offset:6656
    v_xor_b32 v13, 96, v7
    ds_read_b128 v[44:47], v13 offset:8192
    s_waitcnt lgkmcnt(6)
    v_mfma_f32_32x32x16_bf16 v[16:31], v[36:39], v[48:51], v[16:31]
    s_waitcnt lgkmcnt(3)
    v_mfma_f32_32x32x16_bf16 v[16:31], v[40:43], v[52:55], v[16:31]
    s_waitcnt lgkmcnt(0)
    v_mfma_f32_32x32x16_bf16 v[16:31], v[32:35], v[44:47], v[16:31]
    v_and_b32 v10, 31, v2
    s_lshl_b32 s34, s28, 6
    s_lshl_b32 s39, s36, 5
    s_add_u32 s34, s34, s39
    v_add_u32 v10, s34, v10
    v_mul_lo_u32 v10, v10, s30
    v_lshrrev_b32 v11, 5, v2
    v_lshlrev_b32 v11, 3, v11
    v_add_u32 v10, v10, v11
    s_lshl_b32 s34, s29, 7
    s_lshl_b32 s39, s35, 6
    s_add_u32 s34, s34, s39
    v_add_u32 v10, s34, v10
    s_nop 7
    s_nop 3
    s_mov_b32 s34, 0x3ea52b5c
    v_mul_f32 v16, s34, v16
    v_mul_f32 v17, s34, v17
    v_mul_f32 v18, s34, v18
    v_mul_f32 v19, s34, v19
    v_mul_f32 v20, s34, v20
    v_mul_f32 v21, s34, v21
    v_mul_f32 v22, s34, v22
    v_mul_f32 v23, s34, v23
    v_mul_f32 v24, s34, v24
    v_mul_f32 v25, s34, v25
    v_mul_f32 v26, s34, v26
    v_mul_f32 v27, s34, v27
    v_mul_f32 v28, s34, v28
    v_mul_f32 v29, s34, v29
    v_mul_f32 v30, s34, v30
    v_mul_f32 v31, s34, v31
    v_cvt_pk_bf16_f32 v56, v16, v17
    v_cvt_pk_bf16_f32 v57, v18, v19
    v_cvt_pk_bf16_f32 v58, v20, v21
    v_cvt_pk_bf16_f32 v59, v22, v23
    v_cvt_pk_bf16_f32 v60, v24, v25
    v_cvt_pk_bf16_f32 v61, v26, v27
    v_cvt_pk_bf16_f32 v62, v28, v29
    v_cvt_pk_bf16_f32 v63, v30, v31
    buffer_store_dwordx2 v[56:57], v10, s[16:19], 0 offen offset:0
    buffer_store_dwordx2 v[58:59], v10, s[16:19], 0 offen offset:16
    buffer_store_dwordx2 v[60:61], v10, s[16:19], 0 offen offset:32
    buffer_store_dwordx2 v[62:63], v10, s[16:19], 0 offen offset:48
    s_endpgm
K1_ROWS:
    s_mov_b32 s30, 1280
    s_cmp_ge_u32 s2, 448
    s_cbranch_scc1 K1_KV
    s_sub_u32 s28, s2, 320
    s_mov_b32 s40, s26
    s_and_b32 s41, s27, 0xffff
    s_mov_b32 s42, 1280
    s_mov_b32 s43, 0x00020000
    s_add_u32 s44, s20, 2801664
    s_addc_u32 s45, s21, 0
    s_and_b32 s45, s45, 0xffff
    s_mov_b32 s46, 2621440
    s_mov_b32 s47, 0x00020000
    s_add_u32 s48, s20, 5423104
    s_addc_u32 s49, s21, 0
    s_and_b32 s49, s49, 0xffff
    s_mov_b32 s50, 8192
    s_mov_b32 s51, 0x00020000
    v_lshrrev_b32 v4, 4, v0
    v_and_b32 v5, 15, v0
    s_lshl_b32 s34, s28, 4
    v_add_u32 v6, s34, v4
    v_mul_lo_u32 v7, v6, s30
    v_lshlrev_b32 v8, 4, v5
    v_add_u32 v7, v7, v8
    buffer_load_dwordx4 v[24:27], v7, s[8:11], 0 offen offset:0
    buffer_load_dwordx4 v[28:31], v7, s[8:11], 0 offen offset:256
    buffer_load_dwordx4 v[32:35], v7, s[8:11], 0 offen offset:512
    buffer_load_dwordx4 v[36:39], v7, s[8:11], 0 offen offset:768
    buffer_load_dwordx4 v[40:43], v7, s[8:11], 0 offen offset:1024
    buffer_load_dwordx4 v[44:47], v8, s[40:43], 0 offen offset:0
    buffer_load_dwordx4 v[48:51], v8, s[40:43], 0 offen offset:256
    buffer_load_dwordx4 v[52:55], v8, s[40:43], 0 offen offset:512
    buffer_load_dwordx4 v[56:59], v8, s[40:43], 0 offen offset:768
    buffer_load_dwordx4 v[60:63], v8, s[40:43], 0 offen offset:1024
    s_waitcnt vmcnt(5)
    v_mov_b32 v10, 0
    v_mov_b32 v11, 0
    v_lshlrev_b32 v64, 16, v24
    v_and_b32 v65, 0xffff0000, v24
    v_add_f32 v10, v10, v64
    v_add_f32 v10, v10, v65
    v_lshlrev_b32 v66, 16, v25
    v_and_b32 v67, 0xffff0000, v25
    v_add_f32 v10, v10, v66
    v_add_f32 v10, v10, v67
    v_lshlrev_b32 v68, 16, v26
    v_and_b32 v69, 0xffff0000, v26
    v_add_f32 v10, v10, v68
    v_add_f32 v10, v10, v69
    v_lshlrev_b32 v70, 16, v27
    v_and_b32 v71, 0xffff0000, v27
    v_add_f32 v10, v10, v70
    v_add_f32 v10, v10, v71
    v_lshlrev_b32 v72, 16, v28
    v_and_b32 v73, 0xffff0000, v28
    v_add_f32 v10, v10, v72
    v_add_f32 v10, v10, v73
    v_lshlrev_b32 v74, 16, v29
    v_and_b32 v75, 0xffff0000, v29
    v_add_f32 v10, v10, v74
    v_add_f32 v10, v10, v75
    v_lshlrev_b32 v76, 16, v30
    v_and_b32 v77, 0xffff0000, v30
    v_add_f32 v10, v10, v76
    v_add_f32 v10, v10, v77
    v_lshlrev_b32 v78, 16, v31
    v_and_b32 v79, 0xffff0000, v31
    v_add_f32 v10, v10, v78
    v_add_f32 v10, v10, v79
    v_lshlrev_b32 v80, 16, v32
    v_and_b32 v81, 0xffff0000, v32
    v_add_f32 v10, v10, v80
    v_add_f32 v10, v10, v81
    v_lshlrev_b32 v82, 16, v33
    v_and_b32 v83, 0xffff0000, v33
    v_add_f32 v10, v10, v82
    v_add_f32 v10, v10, v83
    v_lshlrev_b32 v84, 16, v34
    v_and_b32 v85, 0xffff0000, v34
    v_add_f32 v10, v10, v84
    v_add_f32 v10, v10, v85
    v_lshlrev_b32 v86, 16, v35
    v_and_b32 v87, 0xffff0000, v35
    v_add_f32 v10, v10, v86
    v_add_f32 v10, v10, v87
    v_lshlrev_b32 v88, 16, v36
    v_and_b32 v89, 0xffff0000, v36
    v_add_f32 v10, v10, v88
    v_add_f32 v10, v10, v89
    v_lshlrev_b32 v90, 16, v37
    v_and_b32 v91, 0xffff0000, v37
    v_add_f32 v10, v10, v90
    v_add_f32 v10, v10, v91
    v_lshlrev_b32 v92, 16, v38
    v_and_b32 v93, 0xffff0000, v38
    v_add_f32 v10, v10, v92
    v_add_f32 v10, v10, v93
    v_lshlrev_b32 v94, 16, v39
    v_and_b32 v95, 0xffff0000, v39
    v_add_f32 v10, v10, v94
    v_add_f32 v10, v10, v95
    v_lshlrev_b32 v96, 16, v40
    v_and_b32 v97, 0xffff0000, v40
    v_add_f32 v10, v10, v96
    v_add_f32 v10, v10, v97
    v_lshlrev_b32 v98, 16, v41
    v_and_b32 v99, 0xffff0000, v41
    v_add_f32 v10, v10, v98
    v_add_f32 v10, v10, v99
    v_lshlrev_b32 v100, 16, v42
    v_and_b32 v101, 0xffff0000, v42
    v_add_f32 v10, v10, v100
    v_add_f32 v10, v10, v101
    v_lshlrev_b32 v102, 16, v43
    v_and_b32 v103, 0xffff0000, v43
    v_add_f32 v10, v10, v102
    v_add_f32 v10, v10, v103
    ds_swizzle_b32 v12, v10 offset:1055
    s_waitcnt lgkmcnt(0)
    v_add_f32 v10, v10, v12
    ds_swizzle_b32 v12, v10 offset:2079
    s_waitcnt lgkmcnt(0)
    v_add_f32 v10, v10, v12
    ds_swizzle_b32 v12, v10 offset:4127
    s_waitcnt lgkmcnt(0)
    v_add_f32 v10, v10, v12
    ds_swizzle_b32 v12, v10 offset:8223
    s_waitcnt lgkmcnt(0)
    v_add_f32 v10, v10, v12
    s_mov_b32 s34, 0x3acccccd
    v_mul_f32 v10, s34, v10
    v_mov_b32 v16, 0
    v_sub_f32 v12, v64, v10
    v_fmac_f32 v16, v12, v12
    v_sub_f32 v12, v65, v10
    v_fmac_f32 v16, v12, v12
    v_sub_f32 v12, v66, v10
    v_fmac_f32 v16, v12, v12
    v_sub_f32 v12, v67, v10
    v_fmac_f32 v16, v12, v12
    v_sub_f32 v12, v68, v10
    v_fmac_f32 v16, v12, v12
    v_sub_f32 v12, v69, v10
    v_fmac_f32 v16, v12, v12
    v_sub_f32 v12, v70, v10
    v_fmac_f32 v16, v12, v12
    v_sub_f32 v12, v71, v10
    v_fmac_f32 v16, v12, v12
    v_sub_f32 v12, v72, v10
    v_fmac_f32 v16, v12, v12
    v_sub_f32 v12, v73, v10
    v_fmac_f32 v16, v12, v12
    v_sub_f32 v12, v74, v10
    v_fmac_f32 v16, v12, v12
    v_sub_f32 v12, v75, v10
    v_fmac_f32 v16, v12, v12
    v_sub_f32 v12, v76, v10
    v_fmac_f32 v16, v12, v12
    v_sub_f32 v12, v77, v10
    v_fmac_f32 v16, v12, v12
    v_sub_f32 v12, v78, v10
    v_fmac_f32 v16, v12, v12
    v_sub_f32 v12, v79, v10
    v_fmac_f32 v16, v12, v12
    v_sub_f32 v12, v80, v10
    v_fmac_f32 v16, v12, v12
    v_sub_f32 v12, v81, v10
    v_fmac_f32 v16, v12, v12
    v_sub_f32 v12, v82, v10
    v_fmac_f32 v16, v12, v12
    v_sub_f32 v12, v83, v10
    v_fmac_f32 v16, v12, v12
    v_sub_f32 v12, v84, v10
    v_fmac_f32 v16, v12, v12
    v_sub_f32 v12, v85, v10
    v_fmac_f32 v16, v12, v12
    v_sub_f32 v12, v86, v10
    v_fmac_f32 v16, v12, v12
    v_sub_f32 v12, v87, v10
    v_fmac_f32 v16, v12, v12
    v_sub_f32 v12, v88, v10
    v_fmac_f32 v16, v12, v12
    v_sub_f32 v12, v89, v10
    v_fmac_f32 v16, v12, v12
    v_sub_f32 v12, v90, v10
    v_fmac_f32 v16, v12, v12
    v_sub_f32 v12, v91, v10
    v_fmac_f32 v16, v12, v12
    v_sub_f32 v12, v92, v10
    v_fmac_f32 v16, v12, v12
    v_sub_f32 v12, v93, v10
    v_fmac_f32 v16, v12, v12
    v_sub_f32 v12, v94, v10
    v_fmac_f32 v16, v12, v12
    v_sub_f32 v12, v95, v10
    v_fmac_f32 v16, v12, v12
    v_sub_f32 v12, v96, v10
    v_fmac_f32 v16, v12, v12
    v_sub_f32 v12, v97, v10
    v_fmac_f32 v16, v12, v12
    v_sub_f32 v12, v98, v10
    v_fmac_f32 v16, v12, v12
    v_sub_f32 v12, v99, v10
    v_fmac_f32 v16, v12, v12
    v_sub_f32 v12, v100, v10
    v_fmac_f32 v16, v12, v12
    v_sub_f32 v12, v101, v10
    v_fmac_f32 v16, v12, v12
    v_sub_f32 v12, v102, v10
    v_fmac_f32 v16, v12, v12
    v_sub_f32 v12, v103, v10
    v_fmac_f32 v16, v12, v12
    ds_swizzle_b32 v12, v16 offset:1055
    s_waitcnt lgkmcnt(0)
    v_add_f32 v16, v16, v12
    ds_swizzle_b32 v12, v16 offset:2079
    s_waitcnt lgkmcnt(0)
    v_add_f32 v16, v16, v12
    ds_swizzle_b32 v12, v16 offset:4127
    s_waitcnt lgkmcnt(0)
    v_add_f32 v16, v16, v12
    ds_swizzle_b32 v12, v16 offset:8223
    s_waitcnt lgkmcnt(0)
    v_add_f32 v16, v16, v12
    s_waitcnt vmcnt(0)
    v_lshlrev_b32 v14, 16, v44
    v_and_b32 v15, 0xffff0000, v44
    v_mul_f32 v14, v64, v14
    v_mul_f32 v15, v65, v15
    v_cvt_pk_bf16_f32 v14, v14, v15
    v_lshlrev_b32 v15, 16, v14
    v_and_b32 v14, 0xffff0000, v14
    v_add_f32 v11, v11, v15
    v_add_f32 v11, v11, v14
    v_lshlrev_b32 v14, 16, v45
    v_and_b32 v15, 0xffff0000, v45
    v_mul_f32 v14, v66, v14
    v_mul_f32 v15, v67, v15
    v_cvt_pk_bf16_f32 v14, v14, v15
    v_lshlrev_b32 v15, 16, v14
    v_and_b32 v14, 0xffff0000, v14
    v_add_f32 v11, v11, v15
    v_add_f32 v11, v11, v14
    v_lshlrev_b32 v14, 16, v46
    v_and_b32 v15, 0xffff0000, v46
    v_mul_f32 v14, v68, v14
    v_mul_f32 v15, v69, v15
    v_cvt_pk_bf16_f32 v14, v14, v15
    v_lshlrev_b32 v15, 16, v14
    v_and_b32 v14, 0xffff0000, v14
    v_add_f32 v11, v11, v15
    v_add_f32 v11, v11, v14
    v_lshlrev_b32 v14, 16, v47
    v_and_b32 v15, 0xffff0000, v47
    v_mul_f32 v14, v70, v14
    v_mul_f32 v15, v71, v15
    v_cvt_pk_bf16_f32 v14, v14, v15
    v_lshlrev_b32 v15, 16, v14
    v_and_b32 v14, 0xffff0000, v14
    v_add_f32 v11, v11, v15
    v_add_f32 v11, v11, v14
    v_lshlrev_b32 v14, 16, v48
    v_and_b32 v15, 0xffff0000, v48
    v_mul_f32 v14, v72, v14
    v_mul_f32 v15, v73, v15
    v_cvt_pk_bf16_f32 v14, v14, v15
    v_lshlrev_b32 v15, 16, v14
    v_and_b32 v14, 0xffff0000, v14
    v_add_f32 v11, v11, v15
    v_add_f32 v11, v11, v14
    v_lshlrev_b32 v14, 16, v49
    v_and_b32 v15, 0xffff0000, v49
    v_mul_f32 v14, v74, v14
    v_mul_f32 v15, v75, v15
    v_cvt_pk_bf16_f32 v14, v14, v15
    v_lshlrev_b32 v15, 16, v14
    v_and_b32 v14, 0xffff0000, v14
    v_add_f32 v11, v11, v15
    v_add_f32 v11, v11, v14
    v_lshlrev_b32 v14, 16, v50
    v_and_b32 v15, 0xffff0000, v50
    v_mul_f32 v14, v76, v14
    v_mul_f32 v15, v77, v15
    v_cvt_pk_bf16_f32 v14, v14, v15
    v_lshlrev_b32 v15, 16, v14
    v_and_b32 v14, 0xffff0000, v14
    v_add_f32 v11, v11, v15
    v_add_f32 v11, v11, v14
    v_lshlrev_b32 v14, 16, v51
    v_and_b32 v15, 0xffff0000, v51
    v_mul_f32 v14, v78, v14
    v_mul_f32 v15, v79, v15
    v_cvt_pk_bf16_f32 v14, v14, v15
    v_lshlrev_b32 v15, 16, v14
    v_and_b32 v14, 0xffff0000, v14
    v_add_f32 v11, v11, v15
    v_add_f32 v11, v11, v14
    v_lshlrev_b32 v14, 16, v52
    v_and_b32 v15, 0xffff0000, v52
    v_mul_f32 v14, v80, v14
    v_mul_f32 v15, v81, v15
    v_cvt_pk_bf16_f32 v14, v14, v15
    v_lshlrev_b32 v15, 16, v14
    v_and_b32 v14, 0xffff0000, v14
    v_add_f32 v11, v11, v15
    v_add_f32 v11, v11, v14
    v_lshlrev_b32 v14, 16, v53
    v_and_b32 v15, 0xffff0000, v53
    v_mul_f32 v14, v82, v14
    v_mul_f32 v15, v83, v15
    v_cvt_pk_bf16_f32 v14, v14, v15
    v_lshlrev_b32 v15, 16, v14
    v_and_b32 v14, 0xffff0000, v14
    v_add_f32 v11, v11, v15
    v_add_f32 v11, v11, v14
    v_lshlrev_b32 v14, 16, v54
    v_and_b32 v15, 0xffff0000, v54
    v_mul_f32 v14, v84, v14
    v_mul_f32 v15, v85, v15
    v_cvt_pk_bf16_f32 v14, v14, v15
    v_lshlrev_b32 v15, 16, v14
    v_and_b32 v14, 0xffff0000, v14
    v_add_f32 v11, v11, v15
    v_add_f32 v11, v11, v14
    v_lshlrev_b32 v14, 16, v55
    v_and_b32 v15, 0xffff0000, v55
    v_mul_f32 v14, v86, v14
    v_mul_f32 v15, v87, v15
    v_cvt_pk_bf16_f32 v14, v14, v15
    v_lshlrev_b32 v15, 16, v14
    v_and_b32 v14, 0xffff0000, v14
    v_add_f32 v11, v11, v15
    v_add_f32 v11, v11, v14
    v_lshlrev_b32 v14, 16, v56
    v_and_b32 v15, 0xffff0000, v56
    v_mul_f32 v14, v88, v14
    v_mul_f32 v15, v89, v15
    v_cvt_pk_bf16_f32 v14, v14, v15
    v_lshlrev_b32 v15, 16, v14
    v_and_b32 v14, 0xffff0000, v14
    v_add_f32 v11, v11, v15
    v_add_f32 v11, v11, v14
    v_lshlrev_b32 v14, 16, v57
    v_and_b32 v15, 0xffff0000, v57
    v_mul_f32 v14, v90, v14
    v_mul_f32 v15, v91, v15
    v_cvt_pk_bf16_f32 v14, v14, v15
    v_lshlrev_b32 v15, 16, v14
    v_and_b32 v14, 0xffff0000, v14
    v_add_f32 v11, v11, v15
    v_add_f32 v11, v11, v14
    v_lshlrev_b32 v14, 16, v58
    v_and_b32 v15, 0xffff0000, v58
    v_mul_f32 v14, v92, v14
    v_mul_f32 v15, v93, v15
    v_cvt_pk_bf16_f32 v14, v14, v15
    v_lshlrev_b32 v15, 16, v14
    v_and_b32 v14, 0xffff0000, v14
    v_add_f32 v11, v11, v15
    v_add_f32 v11, v11, v14
    v_lshlrev_b32 v14, 16, v59
    v_and_b32 v15, 0xffff0000, v59
    v_mul_f32 v14, v94, v14
    v_mul_f32 v15, v95, v15
    v_cvt_pk_bf16_f32 v14, v14, v15
    v_lshlrev_b32 v15, 16, v14
    v_and_b32 v14, 0xffff0000, v14
    v_add_f32 v11, v11, v15
    v_add_f32 v11, v11, v14
    v_lshlrev_b32 v14, 16, v60
    v_and_b32 v15, 0xffff0000, v60
    v_mul_f32 v14, v96, v14
    v_mul_f32 v15, v97, v15
    v_cvt_pk_bf16_f32 v14, v14, v15
    v_lshlrev_b32 v15, 16, v14
    v_and_b32 v14, 0xffff0000, v14
    v_add_f32 v11, v11, v15
    v_add_f32 v11, v11, v14
    v_lshlrev_b32 v14, 16, v61
    v_and_b32 v15, 0xffff0000, v61
    v_mul_f32 v14, v98, v14
    v_mul_f32 v15, v99, v15
    v_cvt_pk_bf16_f32 v14, v14, v15
    v_lshlrev_b32 v15, 16, v14
    v_and_b32 v14, 0xffff0000, v14
    v_add_f32 v11, v11, v15
    v_add_f32 v11, v11, v14
    v_lshlrev_b32 v14, 16, v62
    v_and_b32 v15, 0xffff0000, v62
    v_mul_f32 v14, v100, v14
    v_mul_f32 v15, v101, v15
    v_cvt_pk_bf16_f32 v14, v14, v15
    v_lshlrev_b32 v15, 16, v14
    v_and_b32 v14, 0xffff0000, v14
    v_add_f32 v11, v11, v15
    v_add_f32 v11, v11, v14
    v_lshlrev_b32 v14, 16, v63
    v_and_b32 v15, 0xffff0000, v63
    v_mul_f32 v14, v102, v14
    v_mul_f32 v15, v103, v15
    v_cvt_pk_bf16_f32 v14, v14, v15
    v_lshlrev_b32 v15, 16, v14
    v_and_b32 v14, 0xffff0000, v14
    v_add_f32 v11, v11, v15
    v_add_f32 v11, v11, v14
    ds_swizzle_b32 v12, v11 offset:1055
    s_waitcnt lgkmcnt(0)
    v_add_f32 v11, v11, v12
    ds_swizzle_b32 v12, v11 offset:2079
    s_waitcnt lgkmcnt(0)
    v_add_f32 v11, v11, v12
    ds_swizzle_b32 v12, v11 offset:4127
    s_waitcnt lgkmcnt(0)
    v_add_f32 v11, v11, v12
    ds_swizzle_b32 v12, v11 offset:8223
    s_waitcnt lgkmcnt(0)
    v_add_f32 v11, v11, v12
    v_mul_f32 v16, s34, v16
    v_cvt_pk_bf16_f32 v17, v10, v16
    v_lshlrev_b32 v18, 16, v17
    v_and_b32 v19, 0xffff0000, v17
    v_add_f32 v19, 0x3727c5ac, v19
    v_cvt_pk_bf16_f32 v19, v19, v19
    v_and_b32 v19, 0xffff0000, v19
    v_sqrt_f32 v19, v19
    s_nop 0
    v_cvt_pk_bf16_f32 v19, v19, v19
    v_and_b32 v19, 0xffff0000, v19
    v_rcp_f32 v20, v19
    s_nop 0
    v_sub_f32 v12, v64, v18
    v_sub_f32 v13, v65, v18
    v_cvt_pk_bf16_f32 v12, v12, v13
    v_and_b32 v13, 0xffff0000, v12
    v_lshlrev_b32 v12, 16, v12
    v_mul_f32 v14, v12, v20
    v_mul_f32 v15, v13, v20
    v_fma_f32 v12, -v14, v19, v12
    v_fma_f32 v13, -v15, v19, v13
    v_fma_f32 v14, v12, v20, v14
    v_fma_f32 v15, v13, v20, v15
    v_cvt_pk_bf16_f32 v24, v14, v15
    v_sub_f32 v12, v66, v18
    v_sub_f32 v13, v67, v18
    v_cvt_pk_bf16_f32 v12, v12, v13
    v_and_b32 v13, 0xffff0000, v12
    v_lshlrev_b32 v12, 16, v12
    v_mul_f32 v14, v12, v20
    v_mul_f32 v15, v13, v20
    v_fma_f32 v12, -v14, v19, v12
    v_fma_f32 v13, -v15, v19, v13
    v_fma_f32 v14, v12, v20, v14
    v_fma_f32 v15, v13, v20, v15
    v_cvt_pk_bf16_f32 v25, v14, v15
    v_sub_f32 v12, v68, v18
    v_sub_f32 v13, v69, v18
    v_cvt_pk_bf16_f32 v12, v12, v13
    v_and_b32 v13, 0xffff0000, v12
    v_lshlrev_b32 v12, 16, v12
    v_mul_f32 v14, v12, v20
    v_mul_f32 v15, v13, v20
    v_fma_f32 v12, -v14, v19, v12
    v_fma_f32 v13, -v15, v19, v13
    v_fma_f32 v14, v12, v20, v14
    v_fma_f32 v15, v13, v20, v15
    v_cvt_pk_bf16_f32 v26, v14, v15
    v_sub_f32 v12, v70, v18
    v_sub_f32 v13, v71, v18
    v_cvt_pk_bf16_f32 v12, v12, v13
    v_and_b32 v13, 0xffff0000, v12
    v_lshlrev_b32 v12, 16, v12
    v_mul_f32 v14, v12, v20
    v_mul_f32 v15, v13, v20
    v_fma_f32 v12, -v14, v19, v12
    v_fma_f32 v13, -v15, v19, v13
    v_fma_f32 v14, v12, v20, v14
    v_fma_f32 v15, v13, v20, v15
    v_cvt_pk_bf16_f32 v27, v14, v15
    v_sub_f32 v12, v72, v18
    v_sub_f32 v13, v73, v18
    v_cvt_pk_bf16_f32 v12, v12, v13
    v_and_b32 v13, 0xffff0000, v12
    v_lshlrev_b32 v12, 16, v12
    v_mul_f32 v14, v12, v20
    v_mul_f32 v15, v13, v20
    v_fma_f32 v12, -v14, v19, v12
    v_fma_f32 v13, -v15, v19, v13
    v_fma_f32 v14, v12, v20, v14
    v_fma_f32 v15, v13, v20, v15
    v_cvt_pk_bf16_f32 v28, v14, v15
    v_sub_f32 v12, v74, v18
    v_sub_f32 v13, v75, v18
    v_cvt_pk_bf16_f32 v12, v12, v13
    v_and_b32 v13, 0xffff0000, v12
    v_lshlrev_b32 v12, 16, v12
    v_mul_f32 v14, v12, v20
    v_mul_f32 v15, v13, v20
    v_fma_f32 v12, -v14, v19, v12
    v_fma_f32 v13, -v15, v19, v13
    v_fma_f32 v14, v12, v20, v14
    v_fma_f32 v15, v13, v20, v15
    v_cvt_pk_bf16_f32 v29, v14, v15
    v_sub_f32 v12, v76, v18
    v_sub_f32 v13, v77, v18
    v_cvt_pk_bf16_f32 v12, v12, v13
    v_and_b32 v13, 0xffff0000, v12
    v_lshlrev_b32 v12, 16, v12
    v_mul_f32 v14, v12, v20
    v_mul_f32 v15, v13, v20
    v_fma_f32 v12, -v14, v19, v12
    v_fma_f32 v13, -v15, v19, v13
    v_fma_f32 v14, v12, v20, v14
    v_fma_f32 v15, v13, v20, v15
    v_cvt_pk_bf16_f32 v30, v14, v15
    v_sub_f32 v12, v78, v18
    v_sub_f32 v13, v79, v18
    v_cvt_pk_bf16_f32 v12, v12, v13
    v_and_b32 v13, 0xffff0000, v12
    v_lshlrev_b32 v12, 16, v12
    v_mul_f32 v14, v12, v20
    v_mul_f32 v15, v13, v20
    v_fma_f32 v12, -v14, v19, v12
    v_fma_f32 v13, -v15, v19, v13
    v_fma_f32 v14, v12, v20, v14
    v_fma_f32 v15, v13, v20, v15
    v_cvt_pk_bf16_f32 v31, v14, v15
    v_sub_f32 v12, v80, v18
    v_sub_f32 v13, v81, v18
    v_cvt_pk_bf16_f32 v12, v12, v13
    v_and_b32 v13, 0xffff0000, v12
    v_lshlrev_b32 v12, 16, v12
    v_mul_f32 v14, v12, v20
    v_mul_f32 v15, v13, v20
    v_fma_f32 v12, -v14, v19, v12
    v_fma_f32 v13, -v15, v19, v13
    v_fma_f32 v14, v12, v20, v14
    v_fma_f32 v15, v13, v20, v15
    v_cvt_pk_bf16_f32 v32, v14, v15
    v_sub_f32 v12, v82, v18
    v_sub_f32 v13, v83, v18
    v_cvt_pk_bf16_f32 v12, v12, v13
    v_and_b32 v13, 0xffff0000, v12
    v_lshlrev_b32 v12, 16, v12
    v_mul_f32 v14, v12, v20
    v_mul_f32 v15, v13, v20
    v_fma_f32 v12, -v14, v19, v12
    v_fma_f32 v13, -v15, v19, v13
    v_fma_f32 v14, v12, v20, v14
    v_fma_f32 v15, v13, v20, v15
    v_cvt_pk_bf16_f32 v33, v14, v15
    v_sub_f32 v12, v84, v18
    v_sub_f32 v13, v85, v18
    v_cvt_pk_bf16_f32 v12, v12, v13
    v_and_b32 v13, 0xffff0000, v12
    v_lshlrev_b32 v12, 16, v12
    v_mul_f32 v14, v12, v20
    v_mul_f32 v15, v13, v20
    v_fma_f32 v12, -v14, v19, v12
    v_fma_f32 v13, -v15, v19, v13
    v_fma_f32 v14, v12, v20, v14
    v_fma_f32 v15, v13, v20, v15
    v_cvt_pk_bf16_f32 v34, v14, v15
    v_sub_f32 v12, v86, v18
    v_sub_f32 v13, v87, v18
    v_cvt_pk_bf16_f32 v12, v12, v13
    v_and_b32 v13, 0xffff0000, v12
    v_lshlrev_b32 v12, 16, v12
    v_mul_f32 v14, v12, v20
    v_mul_f32 v15, v13, v20
    v_fma_f32 v12, -v14, v19, v12
    v_fma_f32 v13, -v15, v19, v13
    v_fma_f32 v14, v12, v20, v14
    v_fma_f32 v15, v13, v20, v15
    v_cvt_pk_bf16_f32 v35, v14, v15
    v_sub_f32 v12, v88, v18
    v_sub_f32 v13, v89, v18
    v_cvt_pk_bf16_f32 v12, v12, v13
    v_and_b32 v13, 0xffff0000, v12
    v_lshlrev_b32 v12, 16, v12
    v_mul_f32 v14, v12, v20
    v_mul_f32 v15, v13, v20
    v_fma_f32 v12, -v14, v19, v12
    v_fma_f32 v13, -v15, v19, v13
    v_fma_f32 v14, v12, v20, v14
    v_fma_f32 v15, v13, v20, v15
    v_cvt_pk_bf16_f32 v36, v14, v15
    v_sub_f32 v12, v90, v18
    v_sub_f32 v13, v91, v18
    v_cvt_pk_bf16_f32 v12, v12, v13
    v_and_b32 v13, 0xffff0000, v12
    v_lshlrev_b32 v12, 16, v12
    v_mul_f32 v14, v12, v20
    v_mul_f32 v15, v13, v20
    v_fma_f32 v12, -v14, v19, v12
    v_fma_f32 v13, -v15, v19, v13
    v_fma_f32 v14, v12, v20, v14
    v_fma_f32 v15, v13, v20, v15
    v_cvt_pk_bf16_f32 v37, v14, v15
    v_sub_f32 v12, v92, v18
    v_sub_f32 v13, v93, v18
    v_cvt_pk_bf16_f32 v12, v12, v13
    v_and_b32 v13, 0xffff0000, v12
    v_lshlrev_b32 v12, 16, v12
    v_mul_f32 v14, v12, v20
    v_mul_f32 v15, v13, v20
    v_fma_f32 v12, -v14, v19, v12
    v_fma_f32 v13, -v15, v19, v13
    v_fma_f32 v14, v12, v20, v14
    v_fma_f32 v15, v13, v20, v15
    v_cvt_pk_bf16_f32 v38, v14, v15
    v_sub_f32 v12, v94, v18
    v_sub_f32 v13, v95, v18
    v_cvt_pk_bf16_f32 v12, v12, v13
    v_and_b32 v13, 0xffff0000, v12
    v_lshlrev_b32 v12, 16, v12
    v_mul_f32 v14, v12, v20
    v_mul_f32 v15, v13, v20
    v_fma_f32 v12, -v14, v19, v12
    v_fma_f32 v13, -v15, v19, v13
    v_fma_f32 v14, v12, v20, v14
    v_fma_f32 v15, v13, v20, v15
    v_cvt_pk_bf16_f32 v39, v14, v15
    v_sub_f32 v12, v96, v18
    v_sub_f32 v13, v97, v18
    v_cvt_pk_bf16_f32 v12, v12, v13
    v_and_b32 v13, 0xffff0000, v12
    v_lshlrev_b32 v12, 16, v12
    v_mul_f32 v14, v12, v20
    v_mul_f32 v15, v13, v20
    v_fma_f32 v12, -v14, v19, v12
    v_fma_f32 v13, -v15, v19, v13
    v_fma_f32 v14, v12, v20, v14
    v_fma_f32 v15, v13, v20, v15
    v_cvt_pk_bf16_f32 v40, v14, v15
    v_sub_f32 v12, v98, v18
    v_sub_f32 v13, v99, v18
    v_cvt_pk_bf16_f32 v12, v12, v13
    v_and_b32 v13, 0xffff0000, v12
    v_lshlrev_b32 v12, 16, v12
    v_mul_f32 v14, v12, v20
    v_mul_f32 v15, v13, v20
    v_fma_f32 v12, -v14, v19, v12
    v_fma_f32 v13, -v15, v19, v13
    v_fma_f32 v14, v12, v20, v14
    v_fma_f32 v15, v13, v20, v15
    v_cvt_pk_bf16_f32 v41, v14, v15
    v_sub_f32 v12, v100, v18
    v_sub_f32 v13, v101, v18
    v_cvt_pk_bf16_f32 v12, v12, v13
    v_and_b32 v13, 0xffff0000, v12
    v_lshlrev_b32 v12, 16, v12
    v_mul_f32 v14, v12, v20
    v_mul_f32 v15, v13, v20
    v_fma_f32 v12, -v14, v19, v12
    v_fma_f32 v13, -v15, v19, v13
    v_fma_f32 v14, v12, v20, v14
    v_fma_f32 v15, v13, v20, v15
    v_cvt_pk_bf16_f32 v42, v14, v15
    v_sub_f32 v12, v102, v18
    v_sub_f32 v13, v103, v18
    v_cvt_pk_bf16_f32 v12, v12, v13
    v_and_b32 v13, 0xffff0000, v12
    v_lshlrev_b32 v12, 16, v12
    v_mul_f32 v14, v12, v20
    v_mul_f32 v15, v13, v20
    v_fma_f32 v12, -v14, v19, v12
    v_fma_f32 v13, -v15, v19, v13
    v_fma_f32 v14, v12, v20, v14
    v_fma_f32 v15, v13, v20, v15
    v_cvt_pk_bf16_f32 v43, v14, v15
    buffer_store_dwordx4 v[24:27], v7, s[44:47], 0 offen offset:0
    buffer_store_dwordx4 v[28:31], v7, s[44:47], 0 offen offset:256
    buffer_store_dwordx4 v[32:35], v7, s[44:47], 0 offen offset:512
    buffer_store_dwordx4 v[36:39], v7, s[44:47], 0 offen offset:768
    buffer_store_dwordx4 v[40:43], v7, s[44:47], 0 offen offset:1024
    v_cvt_pk_bf16_f32 v11, v11, v11
    v_and_b32 v11, 0xffff0000, v11
    v_mul_f32 v11, 0xbfb8aa3b, v11
    v_exp_f32 v11, v11
    s_nop 0
    v_add_f32 v11, 1.0, v11
    v_rcp_f32 v11, v11
    s_nop 0
    v_cvt_pk_bf16_f32 v11, v11, v11
    v_and_b32 v11, 0xffff0000, v11
    v_lshlrev_b32 v12, 2, v6
    v_cmp_eq_u32 vcc, 0, v5
    s_and_saveexec_b64 s[36:37], vcc
    buffer_store_dword v11, v12, s[48:51], 0 offen
    s_endpgm
K1_KV:
    s_cmp_ge_u32 s2, 512
    s_cbranch_scc1 K1_PF
    s_sub_u32 s28, s2, 448
    s_mov_b32 s12, s22
    s_and_b32 s13, s23, 0xffff
    s_mov_b32 s14, 25600
    s_mov_b32 s15, 0x00020000
    s_mov_b32 s16, s24
    s_and_b32 s17, s25, 0xffff
    s_mov_b32 s18, 25600
    s_mov_b32 s19, 0x00020000
    s_add_u32 s52, s20, 2621440
    s_addc_u32 s53, s21, 0
    s_and_b32 s53, s53, 0xffff
    s_mov_b32 s54, 65536
    s_mov_b32 s55, 0x00020000
    s_add_u32 s56, s20, 2686976
    s_addc_u32 s57, s21, 0
    s_and_b32 s57, s57, 0xffff
    s_mov_b32 s58, 16384
    s_mov_b32 s59, 0x00020000
    s_add_u32 s60, s20, 2703360
    s_addc_u32 s61, s21, 0
    s_and_b32 s61, s61, 0xffff
    s_mov_b32 s62, 86016
    s_mov_b32 s63, 0x00020000
    s_and_b32 s35, s3, 1
    s_lshr_b32 s36, s3, 1
    v_and_b32 v4, 15, v2
    v_lshrrev_b32 v5, 4, v2
    s_lshl_b32 s34, s28, 5
    s_lshl_b32 s37, s35, 4
    s_add_u32 s39, s34, s37
    v_add_u32 v6, s39, v4
    v_mul_lo_u32 v7, v6, s30
    v_lshlrev_b32 v8, 4, v5
    v_add_u32 v7, v7, v8
    v_lshlrev_b32 v3, 4, v2
    s_lshl_b32 s34, s3, 10
    s_add_u32 s34, s34, 0
    s_mov_b32 m0, s34
    s_nop 0
    buffer_load_dwordx4 v3, s[12:15], s34 offen lds
    s_add_u32 s37, s34, 26112
    s_mov_b32 m0, s37
    s_nop 0
    buffer_load_dwordx4 v3, s[16:19], s34 offen lds
    s_lshl_b32 s34, s3, 10
    s_add_u32 s34, s34, 4096
    s_mov_b32 m0, s34
    s_nop 0
    buffer_load_dwordx4 v3, s[12:15], s34 offen lds
    s_add_u32 s37, s34, 26112
    s_mov_b32 m0, s37
    s_nop 0
    buffer_load_dwordx4 v3, s[16:19], s34 offen lds
    s_lshl_b32 s34, s3, 10
    s_add_u32 s34, s34, 8192
    s_mov_b32 m0, s34
    s_nop 0
    buffer_load_dwordx4 v3, s[12:15], s34 offen lds
    s_add_u32 s37, s34, 26112
    s_mov_b32 m0, s37
    s_nop 0
    buffer_load_dwordx4 v3, s[16:19], s34 offen lds
    s_lshl_b32 s34, s3, 10
    s_add_u32 s34, s34, 12288
    s_mov_b32 m0, s34
    s_nop 0
    buffer_load_dwordx4 v3, s[12:15], s34 offen lds
    s_add_u32 s37, s34, 26112
    s_mov_b32 m0, s37
    s_nop 0
    buffer_load_dwordx4 v3, s[16:19], s34 offen lds
    s_lshl_b32 s34, s3, 10
    s_add_u32 s34, s34, 16384
    s_mov_b32 m0, s34
    s_nop 0
    buffer_load_dwordx4 v3, s[12:15], s34 offen lds
    s_add_u32 s37, s34, 26112
    s_mov_b32 m0, s37
    s_nop 0
    buffer_load_dwordx4 v3, s[16:19], s34 offen lds
    s_lshl_b32 s34, s3, 10
    s_add_u32 s34, s34, 20480
    s_mov_b32 m0, s34
    s_nop 0
    buffer_load_dwordx4 v3, s[12:15], s34 offen lds
    s_add_u32 s37, s34, 26112
    s_mov_b32 m0, s37
    s_nop 0
    buffer_load_dwordx4 v3, s[16:19], s34 offen lds
    s_cmp_ge_u32 s3, 1
    s_cbranch_scc1 K1_SK_7
    s_lshl_b32 s34, s3, 10
    s_add_u32 s34, s34, 24576
    s_mov_b32 m0, s34
    s_nop 0
    buffer_load_dwordx4 v3, s[12:15], s34 offen lds
    s_add_u32 s37, s34, 26112
    s_mov_b32 m0, s37
    s_nop 0
    buffer_load_dwordx4 v3, s[16:19], s34 offen lds
K1_SK_7:
    buffer_load_dwordx4 v[64:67], v7, s[8:11], 0 offen offset:0
    buffer_load_dwordx4 v[68:71], v7, s[8:11], 0 offen offset:64
    buffer_load_dwordx4 v[72:75], v7, s[8:11], 0 offen offset:128
    buffer_load_dwordx4 v[76:79], v7, s[8:11], 0 offen offset:192
    buffer_load_dwordx4 v[80:83], v7, s[8:11], 0 offen offset:256
    buffer_load_dwordx4 v[84:87], v7, s[8:11], 0 offen offset:320
    buffer_load_dwordx4 v[88:91], v7, s[8:11], 0 offen offset:384
    buffer_load_dwordx4 v[92:95], v7, s[8:11], 0 offen offset:448
    buffer_load_dwordx4 v[96:99], v7, s[8:11], 0 offen offset:512
    buffer_load_dwordx4 v[100:103], v7, s[8:11], 0 offen offset:576
    buffer_load_dwordx4 v[104:107], v7, s[8:11], 0 offen offset:640
    buffer_load_dwordx4 v[108:111], v7, s[8:11], 0 offen offset:704
    buffer_load_dwordx4 v[112:115], v7, s[8:11], 0 offen offset:768
    buffer_load_dwordx4 v[116:119], v7, s[8:11], 0 offen offset:832
    buffer_load_dwordx4 v[120:123], v7, s[8:11], 0 offen offset:896
    buffer_load_dwordx4 v[124:127], v7, s[8:11], 0 offen offset:960
    buffer_load_dwordx4 v[128:131], v7, s[8:11], 0 offen offset:1024
    buffer_load_dwordx4 v[132:135], v7, s[8:11], 0 offen offset:1088
    buffer_load_dwordx4 v[136:139], v7, s[8:11], 0 offen offset:1152
    buffer_load_dwordx4 v[140:143], v7, s[8:11], 0 offen offset:1216
    v_lshrrev_b32 v9, 2, v4
    v_lshlrev_b32 v10, 3, v5
    v_add_u32 v9, v9, v10
    v_mul_u32_u24 v9, 40, v9
    v_and_b32 v10, 3, v4
    v_lshlrev_b32 v10, 3, v10
    v_add_u32 v9, v9, v10
    s_mul_i32 s37, s36, 26112
    v_add_u32 v9, s37, v9
    s_waitcnt vmcnt(0)
    s_barrier
    s_cmp_eq_u32 s36, 1
    s_cbranch_scc1 K1_VPATH
    ds_read_b64_tr_b16 v[16:17], v9 offset:0
    ds_read_b64_tr_b16 v[18:19], v9 offset:160
    ds_read_b64_tr_b16 v[20:21], v9 offset:32
    ds_read_b64_tr_b16 v[22:23], v9 offset:192
    ds_read_b64_tr_b16 v[24:25], v9 offset:1280
    ds_read_b64_tr_b16 v[26:27], v9 offset:1440
    ds_read_b64_tr_b16 v[28:29], v9 offset:1312
    ds_read_b64_tr_b16 v[30:31], v9 offset:1472
    ds_read_b64_tr_b16 v[32:33], v9 offset:2560
    ds_read_b64_tr_b16 v[34:35], v9 offset:2720
    ds_read_b64_tr_b16 v[36:37], v9 offset:2592
    ds_read_b64_tr_b16 v[38:39], v9 offset:2752
    s_waitcnt lgkmcnt(8)
    v_mfma_f32_16x16x32_bf16 v[40:43], v[16:19], v[64:67], 0
    v_mfma_f32_16x16x32_bf16 v[44:47], v[20:23], v[64:67], 0
    ds_read_b64_tr_b16 v[16:17], v9 offset:3840
    ds_read_b64_tr_b16 v[18:19], v9 offset:4000
    ds_read_b64_tr_b16 v[20:21], v9 offset:3872
    ds_read_b64_tr_b16 v[22:23], v9 offset:4032
    s_waitcnt lgkmcnt(8)
    v_mfma_f32_16x16x32_bf16 v[40:43], v[24:27], v[68:71], v[40:43]
    v_mfma_f32_16x16x32_bf16 v[44:47], v[28:31], v[68:71], v[44:47]
    ds_read_b64_tr_b16 v[24:25], v9 offset:5120
    ds_read_b64_tr_b16 v[26:27], v9 offset:5280
    ds_read_b64_tr_b16 v[28:29], v9 offset:5152
    ds_read_b64_tr_b16 v[30:31], v9 offset:5312
    s_waitcnt lgkmcnt(8)
    v_mfma_f32_16x16x32_bf16 v[40:43], v[32:35], v[72:75], v[40:43]
    v_mfma_f32_16x16x32_bf16 v[44:47], v[36:39], v[72:75], v[44:47]
    ds_read_b64_tr_b16 v[32:33], v9 offset:6400
    ds_read_b64_tr_b16 v[34:35], v9 offset:6560
    ds_read_b64_tr_b16 v[36:37], v9 offset:6432
    ds_read_b64_tr_b16 v[38:39], v9 offset:6592
    s_waitcnt lgkmcnt(8)
    v_mfma_f32_16x16x32_bf16 v[40:43], v[16:19], v[76:79], v[40:43]
    v_mfma_f32_16x16x32_bf16 v[44:47], v[20:23], v[76:79], v[44:47]
    ds_read_b64_tr_b16 v[16:17], v9 offset:7680
    ds_read_b64_tr_b16 v[18:19], v9 offset:7840
    ds_read_b64_tr_b16 v[20:21], v9 offset:7712
    ds_read_b64_tr_b16 v[22:23], v9 offset:7872
    s_waitcnt lgkmcnt(8)
    v_mfma_f32_16x16x32_bf16 v[40:43], v[24:27], v[80:83], v[40:43]
    v_mfma_f32_16x16x32_bf16 v[44:47], v[28:31], v[80:83], v[44:47]
    ds_read_b64_tr_b16 v[24:25], v9 offset:8960
    ds_read_b64_tr_b16 v[26:27], v9 offset:9120
    ds_read_b64_tr_b16 v[28:29], v9 offset:8992
    ds_read_b64_tr_b16 v[30:31], v9 offset:9152
    s_waitcnt lgkmcnt(8)
    v_mfma_f32_16x16x32_bf16 v[40:43], v[32:35], v[84:87], v[40:43]
    v_mfma_f32_16x16x32_bf16 v[44:47], v[36:39], v[84:87], v[44:47]
    ds_read_b64_tr_b16 v[32:33], v9 offset:10240
    ds_read_b64_tr_b16 v[34:35], v9 offset:10400
    ds_read_b64_tr_b16 v[36:37], v9 offset:10272
    ds_read_b64_tr_b16 v[38:39], v9 offset:10432
    s_waitcnt lgkmcnt(8)
    v_mfma_f32_16x16x32_bf16 v[40:43], v[16:19], v[88:91], v[40:43]
    v_mfma_f32_16x16x32_bf16 v[44:47], v[20:23], v[88:91], v[44:47]
    ds_read_b64_tr_b16 v[16:17], v9 offset:11520
    ds_read_b64_tr_b16 v[18:19], v9 offset:11680
    ds_read_b64_tr_b16 v[20:21], v9 offset:11552
    ds_read_b64_tr_b16 v[22:23], v9 offset:11712
    s_waitcnt lgkmcnt(8)
    v_mfma_f32_16x16x32_bf16 v[40:43], v[24:27], v[92:95], v[40:43]
    v_mfma_f32_16x16x32_bf16 v[44:47], v[28:31], v[92:95], v[44:47]
    ds_read_b64_tr_b16 v[24:25], v9 offset:12800
    ds_read_b64_tr_b16 v[26:27], v9 offset:12960
    ds_read_b64_tr_b16 v[28:29], v9 offset:12832
    ds_read_b64_tr_b16 v[30:31], v9 offset:12992
    s_waitcnt lgkmcnt(8)
    v_mfma_f32_16x16x32_bf16 v[40:43], v[32:35], v[96:99], v[40:43]
    v_mfma_f32_16x16x32_bf16 v[44:47], v[36:39], v[96:99], v[44:47]
    ds_read_b64_tr_b16 v[32:33], v9 offset:14080
    ds_read_b64_tr_b16 v[34:35], v9 offset:14240
    ds_read_b64_tr_b16 v[36:37], v9 offset:14112
    ds_read_b64_tr_b16 v[38:39], v9 offset:14272
    s_waitcnt lgkmcnt(8)
    v_mfma_f32_16x16x32_bf16 v[40:43], v[16:19], v[100:103], v[40:43]
    v_mfma_f32_16x16x32_bf16 v[44:47], v[20:23], v[100:103], v[44:47]
    ds_read_b64_tr_b16 v[16:17], v9 offset:15360
    ds_read_b64_tr_b16 v[18:19], v9 offset:15520
    ds_read_b64_tr_b16 v[20:21], v9 offset:15392
    ds_read_b64_tr_b16 v[22:23], v9 offset:15552
    s_waitcnt lgkmcnt(8)
    v_mfma_f32_16x16x32_bf16 v[40:43], v[24:27], v[104:107], v[40:43]
    v_mfma_f32_16x16x32_bf16 v[44:47], v[28:31], v[104:107], v[44:47]
    ds_read_b64_tr_b16 v[24:25], v9 offset:16640
    ds_read_b64_tr_b16 v[26:27], v9 offset:16800
    ds_read_b64_tr_b16 v[28:29], v9 offset:16672
    ds_read_b64_tr_b16 v[30:31], v9 offset:16832
    s_waitcnt lgkmcnt(8)
    v_mfma_f32_16x16x32_bf16 v[40:43], v[32:35], v[108:111], v[40:43]
    v_mfma_f32_16x16x32_bf16 v[44:47], v[36:39], v[108:111], v[44:47]
    ds_read_b64_tr_b16 v[32:33], v9 offset:17920
    ds_read_b64_tr_b16 v[34:35], v9 offset:18080
    ds_read_b64_tr_b16 v[36:37], v9 offset:17952
    ds_read_b64_tr_b16 v[38:39], v9 offset:18112
    s_waitcnt lgkmcnt(8)
    v_mfma_f32_16x16x32_bf16 v[40:43], v[16:19], v[112:115], v[40:43]
    v_mfma_f32_16x16x32_bf16 v[44:47], v[20:23], v[112:115], v[44:47]
    ds_read_b64_tr_b16 v[16:17], v9 offset:19200
    ds_read_b64_tr_b16 v[18:19], v9 offset:19360
    ds_read_b64_tr_b16 v[20:21], v9 offset:19232
    ds_read_b64_tr_b16 v[22:23], v9 offset:19392
    s_waitcnt lgkmcnt(8)
    v_mfma_f32_16x16x32_bf16 v[40:43], v[24:27], v[116:119], v[40:43]
    v_mfma_f32_16x16x32_bf16 v[44:47], v[28:31], v[116:119], v[44:47]
    ds_read_b64_tr_b16 v[24:25], v9 offset:20480
    ds_read_b64_tr_b16 v[26:27], v9 offset:20640
    ds_read_b64_tr_b16 v[28:29], v9 offset:20512
    ds_read_b64_tr_b16 v[30:31], v9 offset:20672
    s_waitcnt lgkmcnt(8)
    v_mfma_f32_16x16x32_bf16 v[40:43], v[32:35], v[120:123], v[40:43]
    v_mfma_f32_16x16x32_bf16 v[44:47], v[36:39], v[120:123], v[44:47]
    ds_read_b64_tr_b16 v[32:33], v9 offset:21760
    ds_read_b64_tr_b16 v[34:35], v9 offset:21920
    ds_read_b64_tr_b16 v[36:37], v9 offset:21792
    ds_read_b64_tr_b16 v[38:39], v9 offset:21952
    s_waitcnt lgkmcnt(8)
    v_mfma_f32_16x16x32_bf16 v[40:43], v[16:19], v[124:127], v[40:43]
    v_mfma_f32_16x16x32_bf16 v[44:47], v[20:23], v[124:127], v[44:47]
    ds_read_b64_tr_b16 v[16:17], v9 offset:23040
    ds_read_b64_tr_b16 v[18:19], v9 offset:23200
    ds_read_b64_tr_b16 v[20:21], v9 offset:23072
    ds_read_b64_tr_b16 v[22:23], v9 offset:23232
    s_waitcnt lgkmcnt(8)
    v_mfma_f32_16x16x32_bf16 v[40:43], v[24:27], v[128:131], v[40:43]
    v_mfma_f32_16x16x32_bf16 v[44:47], v[28:31], v[128:131], v[44:47]
    ds_read_b64_tr_b16 v[24:25], v9 offset:24320
    ds_read_b64_tr_b16 v[26:27], v9 offset:24480
    ds_read_b64_tr_b16 v[28:29], v9 offset:24352
    ds_read_b64_tr_b16 v[30:31], v9 offset:24512
    s_waitcnt lgkmcnt(8)
    v_mfma_f32_16x16x32_bf16 v[40:43], v[32:35], v[132:135], v[40:43]
    v_mfma_f32_16x16x32_bf16 v[44:47], v[36:39], v[132:135], v[44:47]
    s_waitcnt lgkmcnt(4)
    v_mfma_f32_16x16x32_bf16 v[40:43], v[16:19], v[136:139], v[40:43]
    v_mfma_f32_16x16x32_bf16 v[44:47], v[20:23], v[136:139], v[44:47]
    s_waitcnt lgkmcnt(0)
    v_mfma_f32_16x16x32_bf16 v[40:43], v[24:27], v[140:143], v[40:43]
    v_mfma_f32_16x16x32_bf16 v[44:47], v[28:31], v[140:143], v[44:47]
    s_nop 7
    s_nop 1
    v_cvt_pk_bf16_f32 v48, v40, v41
    v_cvt_pk_bf16_f32 v49, v42, v43
    v_cvt_pk_bf16_f32 v50, v44, v45
    v_cvt_pk_bf16_f32 v51, v46, v47
    v_lshlrev_b32 v10, 5, v6
    v_lshlrev_b32 v11, 3, v5
    v_add_u32 v10, v10, v11
    v_lshlrev_b32 v11, 3, v6
    buffer_store_dwordx2 v[48:49], v10, s[52:55], 0 offen
    v_cmp_gt_u32 vcc, 16, v2
    s_and_saveexec_b64 s[38:39], vcc
    buffer_store_dwordx2 v[50:51], v11, s[56:59], 0 offen
    s_endpgm
K1_VPATH:
    ds_read_b64_tr_b16 v[16:17], v9 offset:0
    ds_read_b64_tr_b16 v[18:19], v9 offset:160
    ds_read_b64_tr_b16 v[20:21], v9 offset:32
    ds_read_b64_tr_b16 v[22:23], v9 offset:192
    ds_read_b64_tr_b16 v[24:25], v9 offset:1280
    ds_read_b64_tr_b16 v[26:27], v9 offset:1440
    ds_read_b64_tr_b16 v[28:29], v9 offset:1312
    ds_read_b64_tr_b16 v[30:31], v9 offset:1472
    ds_read_b64_tr_b16 v[32:33], v9 offset:2560
    ds_read_b64_tr_b16 v[34:35], v9 offset:2720
    ds_read_b64_tr_b16 v[36:37], v9 offset:2592
    ds_read_b64_tr_b16 v[38:39], v9 offset:2752
    s_waitcnt lgkmcnt(8)
    v_mfma_f32_16x16x32_bf16 v[40:43], v[64:67], v[16:19], 0
    v_mfma_f32_16x16x32_bf16 v[44:47], v[64:67], v[20:23], 0
    ds_read_b64_tr_b16 v[16:17], v9 offset:3840
    ds_read_b64_tr_b16 v[18:19], v9 offset:4000
    ds_read_b64_tr_b16 v[20:21], v9 offset:3872
    ds_read_b64_tr_b16 v[22:23], v9 offset:4032
    s_waitcnt lgkmcnt(8)
    v_mfma_f32_16x16x32_bf16 v[40:43], v[68:71], v[24:27], v[40:43]
    v_mfma_f32_16x16x32_bf16 v[44:47], v[68:71], v[28:31], v[44:47]
    ds_read_b64_tr_b16 v[24:25], v9 offset:5120
    ds_read_b64_tr_b16 v[26:27], v9 offset:5280
    ds_read_b64_tr_b16 v[28:29], v9 offset:5152
    ds_read_b64_tr_b16 v[30:31], v9 offset:5312
    s_waitcnt lgkmcnt(8)
    v_mfma_f32_16x16x32_bf16 v[40:43], v[72:75], v[32:35], v[40:43]
    v_mfma_f32_16x16x32_bf16 v[44:47], v[72:75], v[36:39], v[44:47]
    ds_read_b64_tr_b16 v[32:33], v9 offset:6400
    ds_read_b64_tr_b16 v[34:35], v9 offset:6560
    ds_read_b64_tr_b16 v[36:37], v9 offset:6432
    ds_read_b64_tr_b16 v[38:39], v9 offset:6592
    s_waitcnt lgkmcnt(8)
    v_mfma_f32_16x16x32_bf16 v[40:43], v[76:79], v[16:19], v[40:43]
    v_mfma_f32_16x16x32_bf16 v[44:47], v[76:79], v[20:23], v[44:47]
    ds_read_b64_tr_b16 v[16:17], v9 offset:7680
    ds_read_b64_tr_b16 v[18:19], v9 offset:7840
    ds_read_b64_tr_b16 v[20:21], v9 offset:7712
    ds_read_b64_tr_b16 v[22:23], v9 offset:7872
    s_waitcnt lgkmcnt(8)
    v_mfma_f32_16x16x32_bf16 v[40:43], v[80:83], v[24:27], v[40:43]
    v_mfma_f32_16x16x32_bf16 v[44:47], v[80:83], v[28:31], v[44:47]
    ds_read_b64_tr_b16 v[24:25], v9 offset:8960
    ds_read_b64_tr_b16 v[26:27], v9 offset:9120
    ds_read_b64_tr_b16 v[28:29], v9 offset:8992
    ds_read_b64_tr_b16 v[30:31], v9 offset:9152
    s_waitcnt lgkmcnt(8)
    v_mfma_f32_16x16x32_bf16 v[40:43], v[84:87], v[32:35], v[40:43]
    v_mfma_f32_16x16x32_bf16 v[44:47], v[84:87], v[36:39], v[44:47]
    ds_read_b64_tr_b16 v[32:33], v9 offset:10240
    ds_read_b64_tr_b16 v[34:35], v9 offset:10400
    ds_read_b64_tr_b16 v[36:37], v9 offset:10272
    ds_read_b64_tr_b16 v[38:39], v9 offset:10432
    s_waitcnt lgkmcnt(8)
    v_mfma_f32_16x16x32_bf16 v[40:43], v[88:91], v[16:19], v[40:43]
    v_mfma_f32_16x16x32_bf16 v[44:47], v[88:91], v[20:23], v[44:47]
    ds_read_b64_tr_b16 v[16:17], v9 offset:11520
    ds_read_b64_tr_b16 v[18:19], v9 offset:11680
    ds_read_b64_tr_b16 v[20:21], v9 offset:11552
    ds_read_b64_tr_b16 v[22:23], v9 offset:11712
    s_waitcnt lgkmcnt(8)
    v_mfma_f32_16x16x32_bf16 v[40:43], v[92:95], v[24:27], v[40:43]
    v_mfma_f32_16x16x32_bf16 v[44:47], v[92:95], v[28:31], v[44:47]
    ds_read_b64_tr_b16 v[24:25], v9 offset:12800
    ds_read_b64_tr_b16 v[26:27], v9 offset:12960
    ds_read_b64_tr_b16 v[28:29], v9 offset:12832
    ds_read_b64_tr_b16 v[30:31], v9 offset:12992
    s_waitcnt lgkmcnt(8)
    v_mfma_f32_16x16x32_bf16 v[40:43], v[96:99], v[32:35], v[40:43]
    v_mfma_f32_16x16x32_bf16 v[44:47], v[96:99], v[36:39], v[44:47]
    ds_read_b64_tr_b16 v[32:33], v9 offset:14080
    ds_read_b64_tr_b16 v[34:35], v9 offset:14240
    ds_read_b64_tr_b16 v[36:37], v9 offset:14112
    ds_read_b64_tr_b16 v[38:39], v9 offset:14272
    s_waitcnt lgkmcnt(8)
    v_mfma_f32_16x16x32_bf16 v[40:43], v[100:103], v[16:19], v[40:43]
    v_mfma_f32_16x16x32_bf16 v[44:47], v[100:103], v[20:23], v[44:47]
    ds_read_b64_tr_b16 v[16:17], v9 offset:15360
    ds_read_b64_tr_b16 v[18:19], v9 offset:15520
    ds_read_b64_tr_b16 v[20:21], v9 offset:15392
    ds_read_b64_tr_b16 v[22:23], v9 offset:15552
    s_waitcnt lgkmcnt(8)
    v_mfma_f32_16x16x32_bf16 v[40:43], v[104:107], v[24:27], v[40:43]
    v_mfma_f32_16x16x32_bf16 v[44:47], v[104:107], v[28:31], v[44:47]
    ds_read_b64_tr_b16 v[24:25], v9 offset:16640
    ds_read_b64_tr_b16 v[26:27], v9 offset:16800
    ds_read_b64_tr_b16 v[28:29], v9 offset:16672
    ds_read_b64_tr_b16 v[30:31], v9 offset:16832
    s_waitcnt lgkmcnt(8)
    v_mfma_f32_16x16x32_bf16 v[40:43], v[108:111], v[32:35], v[40:43]
    v_mfma_f32_16x16x32_bf16 v[44:47], v[108:111], v[36:39], v[44:47]
    ds_read_b64_tr_b16 v[32:33], v9 offset:17920
    ds_read_b64_tr_b16 v[34:35], v9 offset:18080
    ds_read_b64_tr_b16 v[36:37], v9 offset:17952
    ds_read_b64_tr_b16 v[38:39], v9 offset:18112
    s_waitcnt lgkmcnt(8)
    v_mfma_f32_16x16x32_bf16 v[40:43], v[112:115], v[16:19], v[40:43]
    v_mfma_f32_16x16x32_bf16 v[44:47], v[112:115], v[20:23], v[44:47]
    ds_read_b64_tr_b16 v[16:17], v9 offset:19200
    ds_read_b64_tr_b16 v[18:19], v9 offset:19360
    ds_read_b64_tr_b16 v[20:21], v9 offset:19232
    ds_read_b64_tr_b16 v[22:23], v9 offset:19392
    s_waitcnt lgkmcnt(8)
    v_mfma_f32_16x16x32_bf16 v[40:43], v[116:119], v[24:27], v[40:43]
    v_mfma_f32_16x16x32_bf16 v[44:47], v[116:119], v[28:31], v[44:47]
    ds_read_b64_tr_b16 v[24:25], v9 offset:20480
    ds_read_b64_tr_b16 v[26:27], v9 offset:20640
    ds_read_b64_tr_b16 v[28:29], v9 offset:20512
    ds_read_b64_tr_b16 v[30:31], v9 offset:20672
    s_waitcnt lgkmcnt(8)
    v_mfma_f32_16x16x32_bf16 v[40:43], v[120:123], v[32:35], v[40:43]
    v_mfma_f32_16x16x32_bf16 v[44:47], v[120:123], v[36:39], v[44:47]
    ds_read_b64_tr_b16 v[32:33], v9 offset:21760
    ds_read_b64_tr_b16 v[34:35], v9 offset:21920
    ds_read_b64_tr_b16 v[36:37], v9 offset:21792
    ds_read_b64_tr_b16 v[38:39], v9 offset:21952
    s_waitcnt lgkmcnt(8)
    v_mfma_f32_16x16x32_bf16 v[40:43], v[124:127], v[16:19], v[40:43]
    v_mfma_f32_16x16x32_bf16 v[44:47], v[124:127], v[20:23], v[44:47]
    ds_read_b64_tr_b16 v[16:17], v9 offset:23040
    ds_read_b64_tr_b16 v[18:19], v9 offset:23200
    ds_read_b64_tr_b16 v[20:21], v9 offset:23072
    ds_read_b64_tr_b16 v[22:23], v9 offset:23232
    s_waitcnt lgkmcnt(8)
    v_mfma_f32_16x16x32_bf16 v[40:43], v[128:131], v[24:27], v[40:43]
    v_mfma_f32_16x16x32_bf16 v[44:47], v[128:131], v[28:31], v[44:47]
    ds_read_b64_tr_b16 v[24:25], v9 offset:24320
    ds_read_b64_tr_b16 v[26:27], v9 offset:24480
    ds_read_b64_tr_b16 v[28:29], v9 offset:24352
    ds_read_b64_tr_b16 v[30:31], v9 offset:24512
    s_waitcnt lgkmcnt(8)
    v_mfma_f32_16x16x32_bf16 v[40:43], v[132:135], v[32:35], v[40:43]
    v_mfma_f32_16x16x32_bf16 v[44:47], v[132:135], v[36:39], v[44:47]
    s_waitcnt lgkmcnt(4)
    v_mfma_f32_16x16x32_bf16 v[40:43], v[136:139], v[16:19], v[40:43]
    v_mfma_f32_16x16x32_bf16 v[44:47], v[136:139], v[20:23], v[44:47]
    s_waitcnt lgkmcnt(0)
    v_mfma_f32_16x16x32_bf16 v[40:43], v[140:143], v[24:27], v[40:43]
    v_mfma_f32_16x16x32_bf16 v[44:47], v[140:143], v[28:31], v[44:47]
    s_nop 7
    s_nop 1
    v_cvt_pk_bf16_f32 v48, v40, v41
    v_cvt_pk_bf16_f32 v49, v42, v43
    v_cvt_pk_bf16_f32 v50, v44, v45
    v_cvt_pk_bf16_f32 v51, v46, v47
    v_and_b32 v10, 1, v5
    v_lshlrev_b32 v10, 3, v10
    v_lshrrev_b32 v11, 1, v5
    v_lshlrev_b32 v11, 2, v11
    v_add_u32 v10, v10, v11
    v_add_u32 v10, s39, v10
    v_lshlrev_b32 v10, 1, v10
    v_lshlrev_b32 v11, 12, v4
    v_add_u32 v10, v10, v11
    buffer_store_dwordx2 v[48:49], v10, s[60:63], 0 offen
    v_mov_b32 v12, 0x3f803f80
    v_cmp_eq_u32 vcc, 4, v4
    s_nop 1
    v_cndmask_b32 v50, v50, v12, vcc
    v_cndmask_b32 v51, v51, v12, vcc
    v_add_u32 v10, 0x10000, v10
    v_cmp_gt_u32 vcc, 5, v4
    s_and_saveexec_b64 s[38:39], vcc
    buffer_store_dwordx2 v[50:51], v10, s[60:63], 0 offen
K1_KVDONE:
    s_endpgm
K1_PF:
    s_load_dwordx2 s[4:5], s[0:1], 48
    s_waitcnt lgkmcnt(0)
    s_mov_b32 s12, s4
    s_and_b32 s13, s5, 0xffff
    s_mov_b32 s14, 6291456
    s_mov_b32 s15, 0x00020000
    s_sub_u32 s28, s2, 512
    s_lshl_b32 s28, s28, 2
    s_add_u32 s28, s28, s3
    s_mul_i32 s28, s28, 24576
    v_lshlrev_b32 v3, 7, v2
    buffer_load_dword v4, v3, s[12:15], s28 offen
    s_add_u32 s28, s28, 8192
    buffer_load_dword v5, v3, s[12:15], s28 offen
    s_add_u32 s28, s28, 8192
    buffer_load_dword v6, v3, s[12:15], s28 offen
    s_waitcnt vmcnt(0)
K1_END:
    s_endpgm
.globl k2_kernel
.p2align 8
.type k2_kernel,@function
k2_kernel:
    s_cmp_ge_u32 s2, 256
    s_cbranch_scc1 K2_END
    v_lshrrev_b32 v1, 6, v0
    v_and_b32 v2, 63, v0
    s_nop 0
    v_readfirstlane_b32 s3, v1
    s_load_dwordx2 s[20:21], s[0:1], 104
    s_load_dwordx2 s[4:5], s[0:1], 48
    s_load_dwordx2 s[6:7], s[0:1], 56
    s_load_dwordx2 s[66:67], s[0:1], 64
    s_load_dwordx2 s[68:69], s[0:1], 32
    s_waitcnt lgkmcnt(0)
    s_cmp_ge_u32 s3, 8
    s_cbranch_scc1 K2_LOADER
    s_add_u32 s8, s20, 0
    s_addc_u32 s9, s21, 0
    s_and_b32 s9, s9, 0xffff
    s_mov_b32 s10, 2621440
    s_mov_b32 s11, 0x00020000
    s_add_u32 s12, s20, 7397376
    s_addc_u32 s13, s21, 0
    s_and_b32 s13, s13, 0xffff
    s_mov_b32 s14, 2621440
    s_mov_b32 s15, 0x00020000
    s_add_u32 s16, s20, 10018816
    s_addc_u32 s17, s21, 0
    s_and_b32 s17, s17, 0xffff
    s_mov_b32 s18, 6815744
    s_mov_b32 s19, 0x00020000
    s_lshr_b32 s22, s2, 3
    s_and_b32 s23, s2, 7
    s_lshl_b32 s23, s23, 8
    s_lshl_b32 s24, s3, 5
    s_add_u32 s23, s23, s24
    v_and_b32 v3, 31, v2
    v_lshrrev_b32 v4, 5, v2
    v_add_u32 v5, s23, v3
    s_mov_b32 s25, 1280
    v_mul_lo_u32 v5, v5, s25
    s_mul_i32 s24, s22, 40
    v_add_u32 v5, s24, v5
    s_lshl_b32 s24, s2, 3
    s_add_u32 s24, s24, s3
    s_mul_i32 s24, s24, 3328
    v_lshlrev_b32 v7, 2, v2
    v_lshlrev_b32 v6, 4, v4
    v_add_u32 v6, v5, v6
    buffer_load_dwordx2 v[8:9], v6, s[8:11], 0 offen
    buffer_load_dwordx2 v[10:11], v6, s[8:11], 0 offen offset:8
    buffer_load_dwordx2 v[12:13], v5, s[8:11], 0 offen offset:32
    v_lshlrev_b32 v122, 9, v4
    v_lshlrev_b32 v6, 4, v3
    v_add_u32 v122, v122, v6
    v_lshlrev_b32 v123, 3, v3
    v_mov_b32 v118, v122
    v_mov_b32 v119, v123
    v_add_u32 v120, 13312, v122
    v_add_u32 v121, 13312, v123
    s_mov_b32 s26, 13312
    s_mov_b32 s29, 0
    v_mov_b32 v74, 0
    v_mov_b32 v75, 0
    v_mov_b32 v76, 0
    v_mov_b32 v77, 0
    v_mov_b32 v78, 0
    v_mov_b32 v79, 0
    v_mov_b32 v80, 0
    v_mov_b32 v81, 0
    v_mov_b32 v82, 0
    v_mov_b32 v83, 0
    v_mov_b32 v84, 0
    v_mov_b32 v85, 0
    v_mov_b32 v86, 0
    v_mov_b32 v87, 0
    v_mov_b32 v88, 0
    v_mov_b32 v89, 0
    v_mov_b32 v110, 0
    v_mov_b32 v38, 0
    v_mov_b32 v111, 0
    v_mov_b32 v39, 0
    v_mov_b32 v112, 0
    v_mov_b32 v40, 0
    v_mov_b32 v113, 0
    v_mov_b32 v41, 0
    s_waitcnt vmcnt(0)
    v_cmp_gt_u32 vcc, 32, v2
    s_nop 1
    v_cndmask_b32 v12, 0, v12, vcc
    v_cndmask_b32 v13, 0, v13, vcc
    s_barrier
    ds_read_b128 v[14:17], v118 offset:0
    ds_read_b64 v[18:19], v119 offset:4096
    ds_read_b128 v[20:23], v118 offset:1024
    ds_read_b64 v[24:25], v119 offset:4352
    ds_read_b128 v[26:29], v118 offset:5120
    ds_read_b128 v[30:33], v118 offset:6144
    s_waitcnt lgkmcnt(4)
    v_mfma_f32_32x32x16_bf16 v[42:57], v[14:17], v[8:11], 0
    v_mfma_f32_32x32x8_bf16 v[42:57], v[18:19], v[12:13], v[42:57]
    s_nop 7
    s_nop 4
    v_max3_f32 v116, v42, v43, v44
    v_max3_f32 v114, v45, v46, v47
    v_max3_f32 v116, v116, v48, v49
    v_max3_f32 v114, v114, v50, v51
    v_max3_f32 v116, v116, v52, v53
    v_max3_f32 v114, v114, v54, v55
    v_max3_f32 v116, v116, v56, v57
    v_max_f32 v116, v116, v114
    v_mov_b32 v114, v116
    s_nop 1
    v_permlane32_swap_b32 v116, v114
    v_max_f32 v116, v116, v114
    v_sub_f32 v90, 0, v116
    v_sub_f32 v91, 0, v116
    v_sub_f32 v92, 0, v116
    v_sub_f32 v93, 0, v116
    v_sub_f32 v94, 0, v116
    v_sub_f32 v95, 0, v116
    v_sub_f32 v96, 0, v116
    v_sub_f32 v97, 0, v116
    v_sub_f32 v98, 0, v116
    v_sub_f32 v99, 0, v116
    v_sub_f32 v100, 0, v116
    v_sub_f32 v101, 0, v116
    v_sub_f32 v102, 0, v116
    v_sub_f32 v103, 0, v116
    v_sub_f32 v104, 0, v116
    v_sub_f32 v105, 0, v116
    s_nop 1
    v_mfma_f32_32x32x16_bf16 v[42:57], v[14:17], v[8:11], v[90:105]
    v_mfma_f32_32x32x8_bf16 v[42:57], v[18:19], v[12:13], v[42:57]
    s_nop 7
    s_nop 4
K2_ALOOP:
    s_waitcnt lgkmcnt(2)
    v_mfma_f32_32x32x16_bf16 v[58:73], v[20:23], v[8:11], v[90:105]
    ds_read_b128 v[14:17], v118 offset:2048
    ds_read_b64 v[18:19], v119 offset:4608
    v_exp_f32 v42, v42
    v_exp_f32 v43, v43
    v_exp_f32 v44, v44
    v_exp_f32 v45, v45
    v_exp_f32 v46, v46
    v_mfma_f32_32x32x16_bf16 v[74:89], v[38:41], v[110:113], v[74:89]
    ds_read_b128 v[34:37], v118 offset:7168
    ds_read_b128 v[38:41], v118 offset:8192
    v_exp_f32 v47, v47
    v_exp_f32 v48, v48
    v_exp_f32 v49, v49
    s_nop 0
    v_cvt_pk_bf16_f32 v106, v42, v43
    v_cvt_pk_bf16_f32 v107, v44, v45
    v_cvt_pk_bf16_f32 v108, v46, v47
    v_cvt_pk_bf16_f32 v109, v48, v49
    v_mfma_f32_32x32x8_bf16 v[58:73], v[24:25], v[12:13], v[58:73]
    v_exp_f32 v50, v50
    v_exp_f32 v51, v51
    v_exp_f32 v52, v52
    v_exp_f32 v53, v53
    v_exp_f32 v54, v54
    s_waitcnt lgkmcnt(4)
    v_mfma_f32_32x32x16_bf16 v[74:89], v[26:29], v[106:109], v[74:89]
    v_exp_f32 v55, v55
    v_exp_f32 v56, v56
    v_exp_f32 v57, v57
    s_nop 0
    v_cvt_pk_bf16_f32 v110, v50, v51
    v_cvt_pk_bf16_f32 v111, v52, v53
    v_cvt_pk_bf16_f32 v112, v54, v55
    v_cvt_pk_bf16_f32 v113, v56, v57
    s_waitcnt lgkmcnt(2)
    v_mfma_f32_32x32x16_bf16 v[42:57], v[14:17], v[8:11], v[90:105]
    ds_read_b128 v[20:23], v118 offset:3072
    ds_read_b64 v[24:25], v119 offset:4864
    v_exp_f32 v58, v58
    v_exp_f32 v59, v59
    v_exp_f32 v60, v60
    v_exp_f32 v61, v61
    v_exp_f32 v62, v62
    v_mfma_f32_32x32x16_bf16 v[74:89], v[30:33], v[110:113], v[74:89]
    ds_read_b128 v[26:29], v118 offset:9216
    ds_read_b128 v[30:33], v118 offset:10240
    v_exp_f32 v63, v63
    v_exp_f32 v64, v64
    v_exp_f32 v65, v65
    s_nop 0
    v_cvt_pk_bf16_f32 v106, v58, v59
    v_cvt_pk_bf16_f32 v107, v60, v61
    v_cvt_pk_bf16_f32 v108, v62, v63
    v_cvt_pk_bf16_f32 v109, v64, v65
    v_mfma_f32_32x32x8_bf16 v[42:57], v[18:19], v[12:13], v[42:57]
    v_exp_f32 v66, v66
    v_exp_f32 v67, v67
    v_exp_f32 v68, v68
    v_exp_f32 v69, v69
    v_exp_f32 v70, v70
    s_waitcnt lgkmcnt(4)
    v_mfma_f32_32x32x16_bf16 v[74:89], v[34:37], v[106:109], v[74:89]
    v_exp_f32 v71, v71
    v_exp_f32 v72, v72
    v_exp_f32 v73, v73
    s_nop 0
    v_cvt_pk_bf16_f32 v110, v66, v67
    v_cvt_pk_bf16_f32 v111, v68, v69
    v_cvt_pk_bf16_f32 v112, v70, v71
    v_cvt_pk_bf16_f32 v113, v72, v73
    s_waitcnt lgkmcnt(2)
    v_mfma_f32_32x32x16_bf16 v[58:73], v[20:23], v[8:11], v[90:105]
    ds_read_b128 v[14:17], v120 offset:0
    ds_read_b64 v[18:19], v121 offset:4096
    v_exp_f32 v42, v42
    v_exp_f32 v43, v43
    v_exp_f32 v44, v44
    v_exp_f32 v45, v45
    v_exp_f32 v46, v46
    v_mfma_f32_32x32x16_bf16 v[74:89], v[38:41], v[110:113], v[74:89]
    ds_read_b128 v[34:37], v118 offset:11264
    ds_read_b128 v[38:41], v118 offset:12288
    v_exp_f32 v47, v47
    v_exp_f32 v48, v48
    v_exp_f32 v49, v49
    s_nop 0
    v_cvt_pk_bf16_f32 v106, v42, v43
    v_cvt_pk_bf16_f32 v107, v44, v45
    v_cvt_pk_bf16_f32 v108, v46, v47
    v_cvt_pk_bf16_f32 v109, v48, v49
    v_mfma_f32_32x32x8_bf16 v[58:73], v[24:25], v[12:13], v[58:73]
    v_exp_f32 v50, v50
    v_exp_f32 v51, v51
    v_exp_f32 v52, v52
    v_exp_f32 v53, v53
    v_exp_f32 v54, v54
    s_waitcnt lgkmcnt(4)
    v_mfma_f32_32x32x16_bf16 v[74:89], v[26:29], v[106:109], v[74:89]
    v_exp_f32 v55, v55
    v_exp_f32 v56, v56
    v_exp_f32 v57, v57
    s_nop 0
    v_cvt_pk_bf16_f32 v110, v50, v51
    v_cvt_pk_bf16_f32 v111, v52, v53
    v_cvt_pk_bf16_f32 v112, v54, v55
    v_cvt_pk_bf16_f32 v113, v56, v57
    s_waitcnt lgkmcnt(2)
    v_mfma_f32_32x32x16_bf16 v[42:57], v[14:17], v[8:11], v[90:105]
    ds_read_b128 v[20:23], v120 offset:1024
    ds_read_b64 v[24:25], v121 offset:4352
    v_exp_f32 v58, v58
    v_exp_f32 v59, v59
    v_exp_f32 v60, v60
    v_exp_f32 v61, v61
    v_exp_f32 v62, v62
    v_mfma_f32_32x32x16_bf16 v[74:89], v[30:33], v[110:113], v[74:89]
    ds_read_b128 v[26:29], v120 offset:5120
    ds_read_b128 v[30:33], v120 offset:6144
    v_exp_f32 v63, v63
    v_exp_f32 v64, v64
    v_exp_f32 v65, v65
    s_nop 0
    v_cvt_pk_bf16_f32 v106, v58, v59
    v_cvt_pk_bf16_f32 v107, v60, v61
    v_cvt_pk_bf16_f32 v108, v62, v63
    v_cvt_pk_bf16_f32 v109, v64, v65
    v_mfma_f32_32x32x8_bf16 v[42:57], v[18:19], v[12:13], v[42:57]
    v_exp_f32 v66, v66
    v_exp_f32 v67, v67
    v_exp_f32 v68, v68
    v_exp_f32 v69, v69
    v_exp_f32 v70, v70
    s_waitcnt lgkmcnt(4)
    v_mfma_f32_32x32x16_bf16 v[74:89], v[34:37], v[106:109], v[74:89]
    v_exp_f32 v71, v71
    v_exp_f32 v72, v72
    v_exp_f32 v73, v73
    s_nop 0
    v_cvt_pk_bf16_f32 v110, v66, v67
    v_cvt_pk_bf16_f32 v111, v68, v69
    v_cvt_pk_bf16_f32 v112, v70, v71
    v_cvt_pk_bf16_f32 v113, v72, v73
    v_mov_b32 v118, v120
    v_mov_b32 v119, v121
    s_add_u32 s26, s26, 13312
    s_cmp_ge_u32 s26, 53248
    s_cselect_b32 s26, 0, s26
    v_add_u32 v120, s26, v122
    v_add_u32 v121, s26, v123
    s_add_u32 s29, s29, 1
    s_cmp_lt_u32 s29, 16
    s_cbranch_scc0 K2_AEND
    s_barrier
    s_branch K2_ALOOP
K2_AEND:
    v_mfma_f32_32x32x16_bf16 v[74:89], v[38:41], v[110:113], v[74:89]
    s_waitcnt lgkmcnt(0)
    s_nop 7
    s_nop 7
K2_NORM:
    v_mov_b32 v114, v82
    v_mov_b32 v115, v82
    v_mov_b32 v117, 0x7149f2ca
    s_nop 1
    v_permlane32_swap_b32 v114, v115
    s_cmp_eq_u32 s29, 99
    s_cbranch_scc1 K2_NOCHK
    v_cmp_nlt_f32 vcc, v115, v117
    s_cbranch_vccnz K2_FB
K2_NOCHK:
    v_rcp_f32 v115, v115
    s_nop 0
    v_mul_f32 v74, v74, v115
    v_mul_f32 v75, v75, v115
    v_mul_f32 v76, v76, v115
    v_mul_f32 v77, v77, v115
    v_mul_f32 v78, v78, v115
    v_mul_f32 v79, v79, v115
    v_mul_f32 v80, v80, v115
    v_mul_f32 v81, v81, v115
    v_mul_f32 v82, v82, v115
    v_mul_f32 v83, v83, v115
    v_mul_f32 v84, v84, v115
    v_mul_f32 v85, v85, v115
    v_cvt_pk_bf16_f32 v106, v74, v75
    v_cvt_pk_bf16_f32 v107, v76, v77
    v_cvt_pk_bf16_f32 v108, v78, v79
    v_cvt_pk_bf16_f32 v109, v80, v81
    v_cvt_pk_bf16_f32 v110, v82, v83
    v_cvt_pk_bf16_f32 v111, v84, v85
    v_lshlrev_b32 v6, 3, v4
    v_add_u32 v6, v5, v6
    buffer_store_dwordx2 v[106:107], v6, s[12:15], 0 offen
    buffer_store_dwordx2 v[108:109], v6, s[12:15], 0 offen offset:16
    v_cmp_gt_u32 vcc, 32, v2
    s_and_saveexec_b64 s[30:31], vcc
    buffer_store_dwordx2 v[110:111], v5, s[12:15], 0 offen offset:32
    s_endpgm
K2_FB:
    s_add_u32 s32, s20, 2621440
    s_addc_u32 s33, s21, 0
    s_and_b32 s33, s33, 0xffff
    s_mov_b32 s34, 65536
    s_mov_b32 s35, 0x00020000
    s_add_u32 s36, s20, 2703360
    s_addc_u32 s37, s21, 0
    s_and_b32 s37, s37, 0xffff
    s_mov_b32 s38, 86016
    s_mov_b32 s39, 0x00020000
    s_add_u32 s40, s20, 2686976
    s_addc_u32 s41, s21, 0
    s_and_b32 s41, s41, 0xffff
    s_mov_b32 s42, 16384
    s_mov_b32 s43, 0x00020000
    v_lshlrev_b32 v119, 5, v3
    v_lshlrev_b32 v6, 4, v4
    v_add_u32 v119, v119, v6
    v_lshlrev_b32 v118, 3, v3
    v_lshlrev_b32 v120, 12, v3
    v_add_u32 v120, v120, v6
    v_mov_b32 v117, 0xf149f2ca
    s_mov_b32 s29, 0
    v_mov_b32 v74, 0
    v_mov_b32 v75, 0
    v_mov_b32 v76, 0
    v_mov_b32 v77, 0
    v_mov_b32 v78, 0
    v_mov_b32 v79, 0
    v_mov_b32 v80, 0
    v_mov_b32 v81, 0
    v_mov_b32 v82, 0
    v_mov_b32 v83, 0
    v_mov_b32 v84, 0
    v_mov_b32 v85, 0
    v_mov_b32 v86, 0
    v_mov_b32 v87, 0
    v_mov_b32 v88, 0
    v_mov_b32 v89, 0
K2_FBL:
    s_lshl_b32 s30, s29, 10
    s_lshl_b32 s31, s29, 6
    s_lshl_b32 s28, s29, 8
    buffer_load_dwordx4 v[14:17], v119, s[32:35], s30 offen
    buffer_load_dwordx2 v[18:19], v118, s[40:43], s28 offen
    buffer_load_dwordx4 v[26:29], v120, s[36:39], s31 offen
    buffer_load_dwordx4 v[30:33], v120, s[36:39], s31 offen offset:32
    s_waitcnt vmcnt(0)
    v_mfma_f32_32x32x16_bf16 v[42:57], v[14:17], v[8:11], 0
    v_mfma_f32_32x32x8_bf16 v[42:57], v[18:19], v[12:13], v[42:57]
    s_nop 7
    s_nop 7
    v_max3_f32 v116, v42, v43, v44
    v_max3_f32 v114, v45, v46, v47
    v_max3_f32 v116, v116, v48, v49
    v_max3_f32 v114, v114, v50, v51
    v_max3_f32 v116, v116, v52, v53
    v_max3_f32 v114, v114, v54, v55
    v_max3_f32 v116, v116, v56, v57
    v_max3_f32 v116, v116, v114, v117
    v_mov_b32 v114, v116
    s_nop 1
    v_permlane32_swap_b32 v116, v114
    v_max_f32 v116, v116, v114
    v_sub_f32 v114, v117, v116
    v_exp_f32 v114, v114
    v_mov_b32 v117, v116
    v_mul_f32 v74, v74, v114
    v_mul_f32 v75, v75, v114
    v_mul_f32 v76, v76, v114
    v_mul_f32 v77, v77, v114
    v_mul_f32 v78, v78, v114
    v_mul_f32 v79, v79, v114
    v_mul_f32 v80, v80, v114
    v_mul_f32 v81, v81, v114
    v_mul_f32 v82, v82, v114
    v_mul_f32 v83, v83, v114
    v_mul_f32 v84, v84, v114
    v_mul_f32 v85, v85, v114
    v_sub_f32 v42, v42, v117
    v_exp_f32 v42, v42
    v_sub_f32 v43, v43, v117
    v_exp_f32 v43, v43
    v_sub_f32 v44, v44, v117
    v_exp_f32 v44, v44
    v_sub_f32 v45, v45, v117
    v_exp_f32 v45, v45
    v_sub_f32 v46, v46, v117
    v_exp_f32 v46, v46
    v_sub_f32 v47, v47, v117
    v_exp_f32 v47, v47
    v_sub_f32 v48, v48, v117
    v_exp_f32 v48, v48
    v_sub_f32 v49, v49, v117
    v_exp_f32 v49, v49
    v_sub_f32 v50, v50, v117
    v_exp_f32 v50, v50
    v_sub_f32 v51, v51, v117
    v_exp_f32 v51, v51
    v_sub_f32 v52, v52, v117
    v_exp_f32 v52, v52
    v_sub_f32 v53, v53, v117
    v_exp_f32 v53, v53
    v_sub_f32 v54, v54, v117
    v_exp_f32 v54, v54
    v_sub_f32 v55, v55, v117
    v_exp_f32 v55, v55
    v_sub_f32 v56, v56, v117
    v_exp_f32 v56, v56
    v_sub_f32 v57, v57, v117
    v_exp_f32 v57, v57
    s_nop 0
    v_cvt_pk_bf16_f32 v106, v42, v43
    v_cvt_pk_bf16_f32 v107, v44, v45
    v_cvt_pk_bf16_f32 v108, v46, v47
    v_cvt_pk_bf16_f32 v109, v48, v49
    v_cvt_pk_bf16_f32 v110, v50, v51
    v_cvt_pk_bf16_f32 v111, v52, v53
    v_cvt_pk_bf16_f32 v112, v54, v55
    v_cvt_pk_bf16_f32 v113, v56, v57
    s_nop 1
    v_mfma_f32_32x32x16_bf16 v[74:89], v[26:29], v[106:109], v[74:89]
    v_mfma_f32_32x32x16_bf16 v[74:89], v[30:33], v[110:113], v[74:89]
    s_nop 7
    s_nop 7
    s_add_u32 s29, s29, 1
    s_cmp_lt_u32 s29, 64
    s_cbranch_scc1 K2_FBL
    s_mov_b32 s29, 99
    s_branch K2_NORM
K2_LOADER:
    s_sub_u32 s3, s3, 8
    s_setprio 3
    s_add_u32 s8, s20, 2621440
    s_addc_u32 s9, s21, 0
    s_and_b32 s9, s9, 0xffff
    s_mov_b32 s10, 65536
    s_mov_b32 s11, 0x00020000
    s_add_u32 s12, s20, 2686976
    s_addc_u32 s13, s21, 0
    s_and_b32 s13, s13, 0xffff
    s_mov_b32 s14, 16384
    s_mov_b32 s15, 0x00020000
    s_add_u32 s16, s20, 2703360
    s_addc_u32 s17, s21, 0
    s_and_b32 s17, s17, 0xffff
    s_mov_b32 s18, 86016
    s_mov_b32 s19, 0x00020000
    s_add_u32 s40, s20, 2801664
    s_addc_u32 s41, s21, 0
    s_and_b32 s41, s41, 0xffff
    s_mov_b32 s42, 2621440
    s_mov_b32 s43, 0x00020000
    s_mov_b32 s44, s4
    s_and_b32 s45, s5, 0xffff
    s_mov_b32 s46, 6291456
    s_mov_b32 s47, 0x00020000
    s_mov_b32 s48, s6
    s_and_b32 s49, s7, 0xffff
    s_mov_b32 s50, 3072
    s_mov_b32 s51, 0x00020000
    s_add_u32 s52, s20, 5431296
    s_addc_u32 s53, s21, 0
    s_and_b32 s53, s53, 0xffff
    s_mov_b32 s54, 1966080
    s_mov_b32 s55, 0x00020000
    s_and_b32 s60, s2, 7
    s_lshr_b32 s61, s2, 3
    s_mul_hi_u32 s22, s61, 0x2aaaaaab
    s_mul_i32 s23, s22, 6
    s_sub_u32 s23, s61, s23
    s_lshr_b32 s34, s60, 2
    s_mul_i32 s34, s34, 5
    s_add_u32 s22, s22, s34
    s_and_b32 s34, s60, 3
    s_mul_i32 s34, s34, 6
    s_add_u32 s23, s23, s34
    s_mov_b32 s24, 3072
    s_mov_b32 s25, 1280
    s_mul_i32 s31, s3, 98304
    s_lshl_b32 s34, s23, 7
    s_add_u32 s31, s31, s34
    s_mul_i32 s32, s3, 40960
    s_lshl_b32 s34, s22, 7
    s_add_u32 s32, s32, s34
    s_lshl_b32 s33, s3, 12
    s_and_b32 s35, s3, 1
    s_lshr_b32 s36, s3, 1
    s_mov_b32 s37, s35
    s_mov_b32 s38, s36
    v_lshrrev_b32 v10, 3, v2
    v_mul_lo_u32 v10, v10, s24
    v_lshrrev_b32 v11, 4, v2
    v_and_b32 v11, 1, v11
    v_lshlrev_b32 v11, 2, v11
    v_and_b32 v3, 7, v2
    v_xor_b32 v3, v3, v11
    v_lshlrev_b32 v3, 4, v3
    v_add_u32 v3, v3, v10
    v_lshrrev_b32 v10, 3, v2
    v_mul_lo_u32 v10, v10, s25
    v_lshrrev_b32 v11, 4, v2
    v_and_b32 v11, 1, v11
    v_lshlrev_b32 v11, 2, v11
    v_and_b32 v4, 7, v2
    v_xor_b32 v4, v4, v11
    v_lshlrev_b32 v4, 4, v4
    v_add_u32 v4, v4, v10
    v_and_b32 v10, 3, v2
    v_lshlrev_b32 v10, 3, v10
    v_lshrrev_b32 v11, 4, v2
    v_and_b32 v11, 1, v11
    v_lshlrev_b32 v11, 5, v11
    v_add_u32 v10, v10, v11
    s_lshl_b32 s37, s37, 6
    v_add_u32 v10, s37, v10
    v_lshrrev_b32 v11, 3, v2
    v_and_b32 v11, 1, v11
    v_lshlrev_b32 v11, 6, v11
    v_xor_b32 v10, v10, v11
    v_lshrrev_b32 v11, 2, v2
    v_and_b32 v11, 3, v11
    v_lshlrev_b32 v11, 7, v11
    v_add_u32 v10, v10, v11
    v_lshrrev_b32 v11, 5, v2
    v_lshlrev_b32 v11, 10, v11
    v_add_u32 v6, v10, v11
    v_and_b32 v10, 3, v2
    v_lshlrev_b32 v10, 3, v10
    v_lshrrev_b32 v11, 4, v2
    v_and_b32 v11, 1, v11
    v_lshlrev_b32 v11, 5, v11
    v_add_u32 v10, v10, v11
    s_lshl_b32 s38, s38, 6
    v_add_u32 v10, s38, v10
    v_lshrrev_b32 v11, 3, v2
    v_and_b32 v11, 1, v11
    v_lshlrev_b32 v11, 6, v11
    v_xor_b32 v10, v10, v11
    v_lshrrev_b32 v11, 2, v2
    v_and_b32 v11, 3, v11
    v_lshlrev_b32 v11, 7, v11
    v_add_u32 v10, v10, v11
    v_lshrrev_b32 v11, 5, v2
    v_lshlrev_b32 v11, 10, v11
    v_add_u32 v7, v10, v11
    v_add_u32 v6, 53248, v6
    v_add_u32 v7, 53248, v7
    v_add_u32 v12, 0x10000, v6
    v_add_u32 v13, 0x10000, v7
    v_and_b32 v10, 31, v2
    v_lshrrev_b32 v11, 5, v2
    v_lshlrev_b32 v11, 4, v11
    v_lshlrev_b32 v8, 5, v10
    v_add_u32 v8, v8, v11
    v_lshlrev_b32 v9, 4, v2
    v_lshlrev_b32 v5, 12, v10
    v_add_u32 v5, v5, v11
    s_lshl_b32 s58, s3, 10
    s_lshl_b32 s57, s3, 11
    s_lshl_b32 s59, s3, 6
    s_lshl_b32 s34, s3, 4
    s_mov_b32 s62, 0xffff
    s_mov_b32 s63, 0
    s_lshl_b64 s[62:63], s[62:63], s34
    s_cmp_ge_u32 s61, 30
    s_cbranch_scc1 K2_KVONLY
    s_add_u32 m0, s58, 0
    s_add_u32 s34, s58, 0
    buffer_load_dwordx4 v8, s[8:11], s34 offen lds
    s_add_u32 m0, s57, 5120
    s_add_u32 s34, s59, 0
    buffer_load_dwordx4 v5, s[16:19], s34 offen lds
    s_add_u32 m0, s57, 6144
    s_add_u32 s34, s59, 32
    buffer_load_dwordx4 v5, s[16:19], s34 offen lds
    s_mov_b32 m0, 4096
    s_mov_b32 s34, 0
    s_mov_b64 exec, s[62:63]
    buffer_load_dwordx4 v9, s[12:15], s34 offen lds
    s_mov_b64 exec, -1
    s_add_u32 m0, s58, 13312
    s_add_u32 s34, s58, 4096
    buffer_load_dwordx4 v8, s[8:11], s34 offen lds
    s_add_u32 m0, s57, 18432
    s_add_u32 s34, s59, 256
    buffer_load_dwordx4 v5, s[16:19], s34 offen lds
    s_add_u32 m0, s57, 19456
    s_add_u32 s34, s59, 288
    buffer_load_dwordx4 v5, s[16:19], s34 offen lds
    s_mov_b32 m0, 17408
    s_mov_b32 s34, 1024
    s_mov_b64 exec, s[62:63]
    buffer_load_dwordx4 v9, s[12:15], s34 offen lds
    s_mov_b64 exec, -1
    s_add_u32 m0, s33, 53248
    s_add_u32 s34, s31, 0
    buffer_load_dwordx4 v3, s[44:47], s34 offen lds
    s_add_u32 m0, s33, 54272
    s_add_u32 s34, s31, 24576
    buffer_load_dwordx4 v3, s[44:47], s34 offen lds
    s_add_u32 m0, s33, 55296
    s_add_u32 s34, s31, 49152
    buffer_load_dwordx4 v3, s[44:47], s34 offen lds
    s_add_u32 m0, s33, 56320
    s_add_u32 s34, s31, 73728
    buffer_load_dwordx4 v3, s[44:47], s34 offen lds
    s_add_u32 m0, s33, 69632
    s_add_u32 s34, s32, 0
    buffer_load_dwordx4 v4, s[40:43], s34 offen lds
    s_add_u32 m0, s33, 70656
    s_add_u32 s34, s32, 10240
    buffer_load_dwordx4 v4, s[40:43], s34 offen lds
    s_add_u32 m0, s33, 71680
    s_add_u32 s34, s32, 20480
    buffer_load_dwordx4 v4, s[40:43], s34 offen lds
    s_add_u32 m0, s33, 72704
    s_add_u32 s34, s32, 30720
    buffer_load_dwordx4 v4, s[40:43], s34 offen lds
    s_add_u32 m0, s58, 26624
    s_add_u32 s34, s58, 8192
    buffer_load_dwordx4 v8, s[8:11], s34 offen lds
    s_add_u32 m0, s57, 31744
    s_add_u32 s34, s59, 512
    buffer_load_dwordx4 v5, s[16:19], s34 offen lds
    s_add_u32 m0, s57, 32768
    s_add_u32 s34, s59, 544
    buffer_load_dwordx4 v5, s[16:19], s34 offen lds
    s_mov_b32 m0, 30720
    s_mov_b32 s34, 2048
    s_mov_b64 exec, s[62:63]
    buffer_load_dwordx4 v9, s[12:15], s34 offen lds
    s_mov_b64 exec, -1
    s_add_u32 m0, s33, 86016
    s_add_u32 s34, s31, 393216
    buffer_load_dwordx4 v3, s[44:47], s34 offen lds
    s_add_u32 m0, s33, 87040
    s_add_u32 s34, s31, 417792
    buffer_load_dwordx4 v3, s[44:47], s34 offen lds
    s_add_u32 m0, s33, 88064
    s_add_u32 s34, s31, 442368
    buffer_load_dwordx4 v3, s[44:47], s34 offen lds
    s_add_u32 m0, s33, 89088
    s_add_u32 s34, s31, 466944
    buffer_load_dwordx4 v3, s[44:47], s34 offen lds
    s_add_u32 m0, s33, 102400
    s_add_u32 s34, s32, 163840
    buffer_load_dwordx4 v4, s[40:43], s34 offen lds
    s_add_u32 m0, s33, 103424
    s_add_u32 s34, s32, 174080
    buffer_load_dwordx4 v4, s[40:43], s34 offen lds
    s_add_u32 m0, s33, 104448
    s_add_u32 s34, s32, 184320
    buffer_load_dwordx4 v4, s[40:43], s34 offen lds
    s_add_u32 m0, s33, 105472
    s_add_u32 s34, s32, 194560
    buffer_load_dwordx4 v4, s[40:43], s34 offen lds
    s_add_u32 m0, s33, 118784
    s_add_u32 s34, s31, 786432
    buffer_load_dwordx4 v3, s[44:47], s34 offen lds
    s_add_u32 m0, s33, 119808
    s_add_u32 s34, s31, 811008
    buffer_load_dwordx4 v3, s[44:47], s34 offen lds
    s_add_u32 m0, s33, 120832
    s_add_u32 s34, s31, 835584
    buffer_load_dwordx4 v3, s[44:47], s34 offen lds
    s_add_u32 m0, s33, 121856
    s_add_u32 s34, s31, 860160
    buffer_load_dwordx4 v3, s[44:47], s34 offen lds
    s_add_u32 m0, s33, 135168
    s_add_u32 s34, s32, 327680
    buffer_load_dwordx4 v4, s[40:43], s34 offen lds
    s_add_u32 m0, s33, 136192
    s_add_u32 s34, s32, 337920
    buffer_load_dwordx4 v4, s[40:43], s34 offen lds
    s_add_u32 m0, s33, 137216
    s_add_u32 s34, s32, 348160
    buffer_load_dwordx4 v4, s[40:43], s34 offen lds
    s_add_u32 m0, s33, 138240
    s_add_u32 s34, s32, 358400
    buffer_load_dwordx4 v4, s[40:43], s34 offen lds
    s_waitcnt vmcnt(20)
    s_barrier
    ds_read_b64_tr_b16 v[32:33], v6 offset:0
    ds_read_b64_tr_b16 v[34:35], v6 offset:512
    ds_read_b64_tr_b16 v[44:45], v7 offset:16384
    ds_read_b64_tr_b16 v[46:47], v7 offset:16896
    ds_read_b64_tr_b16 v[36:37], v6 offset:2048
    ds_read_b64_tr_b16 v[38:39], v6 offset:2560
    ds_read_b64_tr_b16 v[48:49], v7 offset:18432
    ds_read_b64_tr_b16 v[50:51], v7 offset:18944
    s_add_u32 m0, s58, 39936
    s_add_u32 s34, s58, 12288
    buffer_load_dwordx4 v8, s[8:11], s34 offen lds
    s_add_u32 m0, s57, 45056
    s_add_u32 s34, s59, 768
    buffer_load_dwordx4 v5, s[16:19], s34 offen lds
    ds_read_b64_tr_b16 v[40:41], v6 offset:4096
    ds_read_b64_tr_b16 v[42:43], v6 offset:4608
    ds_read_b64_tr_b16 v[52:53], v7 offset:20480
    ds_read_b64_tr_b16 v[54:55], v7 offset:20992
    s_waitcnt lgkmcnt(8)
    v_mfma_f32_32x32x16_bf16 v[16:31], v[32:35], v[44:47], 0
    s_add_u32 m0, s57, 46080
    s_add_u32 s34, s59, 800
    buffer_load_dwordx4 v5, s[16:19], s34 offen lds
    s_mov_b32 m0, 44032
    s_mov_b32 s34, 3072
    s_mov_b64 exec, s[62:63]
    buffer_load_dwordx4 v9, s[12:15], s34 offen lds
    s_mov_b64 exec, -1
    ds_read_b64_tr_b16 v[32:33], v6 offset:6144
    ds_read_b64_tr_b16 v[34:35], v6 offset:6656
    ds_read_b64_tr_b16 v[44:45], v7 offset:22528
    ds_read_b64_tr_b16 v[46:47], v7 offset:23040
    s_waitcnt lgkmcnt(8)
    v_mfma_f32_32x32x16_bf16 v[16:31], v[36:39], v[48:51], v[16:31]
    ds_read_b64_tr_b16 v[36:37], v6 offset:8192
    ds_read_b64_tr_b16 v[38:39], v6 offset:8704
    ds_read_b64_tr_b16 v[48:49], v7 offset:24576
    ds_read_b64_tr_b16 v[50:51], v7 offset:25088
    s_waitcnt lgkmcnt(8)
    v_mfma_f32_32x32x16_bf16 v[16:31], v[40:43], v[52:55], v[16:31]
    ds_read_b64_tr_b16 v[40:41], v6 offset:10240
    ds_read_b64_tr_b16 v[42:43], v6 offset:10752
    ds_read_b64_tr_b16 v[52:53], v7 offset:26624
    ds_read_b64_tr_b16 v[54:55], v7 offset:27136
    s_waitcnt lgkmcnt(8)
    v_mfma_f32_32x32x16_bf16 v[16:31], v[32:35], v[44:47], v[16:31]
    ds_read_b64_tr_b16 v[32:33], v6 offset:12288
    ds_read_b64_tr_b16 v[34:35], v6 offset:12800
    ds_read_b64_tr_b16 v[44:45], v7 offset:28672
    ds_read_b64_tr_b16 v[46:47], v7 offset:29184
    s_waitcnt lgkmcnt(8)
    v_mfma_f32_32x32x16_bf16 v[16:31], v[36:39], v[48:51], v[16:31]
    ds_read_b64_tr_b16 v[36:37], v6 offset:14336
    ds_read_b64_tr_b16 v[38:39], v6 offset:14848
    ds_read_b64_tr_b16 v[48:49], v7 offset:30720
    ds_read_b64_tr_b16 v[50:51], v7 offset:31232
    s_waitcnt lgkmcnt(8)
    v_mfma_f32_32x32x16_bf16 v[16:31], v[40:43], v[52:55], v[16:31]
    s_waitcnt lgkmcnt(4)
    v_mfma_f32_32x32x16_bf16 v[16:31], v[32:35], v[44:47], v[16:31]
    s_waitcnt lgkmcnt(0)
    v_mfma_f32_32x32x16_bf16 v[16:31], v[36:39], v[48:51], v[16:31]
    s_waitcnt vmcnt(12)
    s_barrier
    ds_read_b64_tr_b16 v[32:33], v6 offset:32768
    ds_read_b64_tr_b16 v[34:35], v6 offset:33280
    ds_read_b64_tr_b16 v[44:45], v7 offset:49152
    ds_read_b64_tr_b16 v[46:47], v7 offset:49664
    ds_read_b64_tr_b16 v[36:37], v6 offset:34816
    ds_read_b64_tr_b16 v[38:39], v6 offset:35328
    ds_read_b64_tr_b16 v[48:49], v7 offset:51200
    ds_read_b64_tr_b16 v[50:51], v7 offset:51712
    s_add_u32 m0, s58, 0
    s_add_u32 s34, s58, 16384
    buffer_load_dwordx4 v8, s[8:11], s34 offen lds
    s_add_u32 m0, s57, 5120
    s_add_u32 s34, s59, 1024
    buffer_load_dwordx4 v5, s[16:19], s34 offen lds
    ds_read_b64_tr_b16 v[40:41], v6 offset:36864
    ds_read_b64_tr_b16 v[42:43], v6 offset:37376
    ds_read_b64_tr_b16 v[52:53], v7 offset:53248
    ds_read_b64_tr_b16 v[54:55], v7 offset:53760
    s_waitcnt lgkmcnt(8)
    v_mfma_f32_32x32x16_bf16 v[16:31], v[32:35], v[44:47], v[16:31]
    s_add_u32 m0, s57, 6144
    s_add_u32 s34, s59, 1056
    buffer_load_dwordx4 v5, s[16:19], s34 offen lds
    s_mov_b32 m0, 4096
    s_mov_b32 s34, 4096
    s_mov_b64 exec, s[62:63]
    buffer_load_dwordx4 v9, s[12:15], s34 offen lds
    s_mov_b64 exec, -1
    ds_read_b64_tr_b16 v[32:33], v6 offset:38912
    ds_read_b64_tr_b16 v[34:35], v6 offset:39424
    ds_read_b64_tr_b16 v[44:45], v7 offset:55296
    ds_read_b64_tr_b16 v[46:47], v7 offset:55808
    s_waitcnt lgkmcnt(8)
    v_mfma_f32_32x32x16_bf16 v[16:31], v[36:39], v[48:51], v[16:31]
    s_add_u32 m0, s33, 53248
    s_add_u32 s34, s31, 1179648
    buffer_load_dwordx4 v3, s[44:47], s34 offen lds
    s_add_u32 m0, s33, 54272
    s_add_u32 s34, s31, 1204224
    buffer_load_dwordx4 v3, s[44:47], s34 offen lds
    ds_read_b64_tr_b16 v[36:37], v6 offset:40960
    ds_read_b64_tr_b16 v[38:39], v6 offset:41472
    ds_read_b64_tr_b16 v[48:49], v7 offset:57344
    ds_read_b64_tr_b16 v[50:51], v7 offset:57856
    s_waitcnt lgkmcnt(8)
    v_mfma_f32_32x32x16_bf16 v[16:31], v[40:43], v[52:55], v[16:31]
    s_add_u32 m0, s33, 55296
    s_add_u32 s34, s31, 1228800
    buffer_load_dwordx4 v3, s[44:47], s34 offen lds
    s_add_u32 m0, s33, 56320
    s_add_u32 s34, s31, 1253376
    buffer_load_dwordx4 v3, s[44:47], s34 offen lds
    ds_read_b64_tr_b16 v[40:41], v6 offset:43008
    ds_read_b64_tr_b16 v[42:43], v6 offset:43520
    ds_read_b64_tr_b16 v[52:53], v7 offset:59392
    ds_read_b64_tr_b16 v[54:55], v7 offset:59904
    s_waitcnt lgkmcnt(8)
    v_mfma_f32_32x32x16_bf16 v[16:31], v[32:35], v[44:47], v[16:31]
    s_add_u32 m0, s33, 69632
    s_add_u32 s34, s32, 491520
    buffer_load_dwordx4 v4, s[40:43], s34 offen lds
    s_add_u32 m0, s33, 70656
    s_add_u32 s34, s32, 501760
    buffer_load_dwordx4 v4, s[40:43], s34 offen lds
    ds_read_b64_tr_b16 v[32:33], v6 offset:45056
    ds_read_b64_tr_b16 v[34:35], v6 offset:45568
    ds_read_b64_tr_b16 v[44:45], v7 offset:61440
    ds_read_b64_tr_b16 v[46:47], v7 offset:61952
    s_waitcnt lgkmcnt(8)
    v_mfma_f32_32x32x16_bf16 v[16:31], v[36:39], v[48:51], v[16:31]
    s_add_u32 m0, s33, 71680
    s_add_u32 s34, s32, 512000
    buffer_load_dwordx4 v4, s[40:43], s34 offen lds
    s_add_u32 m0, s33, 72704
    s_add_u32 s34, s32, 522240
    buffer_load_dwordx4 v4, s[40:43], s34 offen lds
    ds_read_b64_tr_b16 v[36:37], v6 offset:47104
    ds_read_b64_tr_b16 v[38:39], v6 offset:47616
    ds_read_b64_tr_b16 v[48:49], v7 offset:63488
    ds_read_b64_tr_b16 v[50:51], v7 offset:64000
    s_waitcnt lgkmcnt(8)
    v_mfma_f32_32x32x16_bf16 v[16:31], v[40:43], v[52:55], v[16:31]
    s_waitcnt lgkmcnt(4)
    v_mfma_f32_32x32x16_bf16 v[16:31], v[32:35], v[44:47], v[16:31]
    s_waitcnt lgkmcnt(0)
    v_mfma_f32_32x32x16_bf16 v[16:31], v[36:39], v[48:51], v[16:31]
    s_waitcnt vmcnt(12)
    s_barrier
    ds_read_b64_tr_b16 v[32:33], v12 offset:0
    ds_read_b64_tr_b16 v[34:35], v12 offset:512
    ds_read_b64_tr_b16 v[44:45], v13 offset:16384
    ds_read_b64_tr_b16 v[46:47], v13 offset:16896
    ds_read_b64_tr_b16 v[36:37], v12 offset:2048
    ds_read_b64_tr_b16 v[38:39], v12 offset:2560
    ds_read_b64_tr_b16 v[48:49], v13 offset:18432
    ds_read_b64_tr_b16 v[50:51], v13 offset:18944
    s_add_u32 m0, s58, 13312
    s_add_u32 s34, s58, 20480
    buffer_load_dwordx4 v8, s[8:11], s34 offen lds
    s_add_u32 m0, s57, 18432
    s_add_u32 s34, s59, 1280
    buffer_load_dwordx4 v5, s[16:19], s34 offen lds
    ds_read_b64_tr_b16 v[40:41], v12 offset:4096
    ds_read_b64_tr_b16 v[42:43], v12 offset:4608
    ds_read_b64_tr_b16 v[52:53], v13 offset:20480
    ds_read_b64_tr_b16 v[54:55], v13 offset:20992
    s_waitcnt lgkmcnt(8)
    v_mfma_f32_32x32x16_bf16 v[16:31], v[32:35], v[44:47], v[16:31]
    s_add_u32 m0, s57, 19456
    s_add_u32 s34, s59, 1312
    buffer_load_dwordx4 v5, s[16:19], s34 offen lds
    s_mov_b32 m0, 17408
    s_mov_b32 s34, 5120
    s_mov_b64 exec, s[62:63]
    buffer_load_dwordx4 v9, s[12:15], s34 offen lds
    s_mov_b64 exec, -1
    ds_read_b64_tr_b16 v[32:33], v12 offset:6144
    ds_read_b64_tr_b16 v[34:35], v12 offset:6656
    ds_read_b64_tr_b16 v[44:45], v13 offset:22528
    ds_read_b64_tr_b16 v[46:47], v13 offset:23040
    s_waitcnt lgkmcnt(8)
    v_mfma_f32_32x32x16_bf16 v[16:31], v[36:39], v[48:51], v[16:31]
    s_add_u32 m0, s33, 86016
    s_add_u32 s34, s31, 1572864
    buffer_load_dwordx4 v3, s[44:47], s34 offen lds
    s_add_u32 m0, s33, 87040
    s_add_u32 s34, s31, 1597440
    buffer_load_dwordx4 v3, s[44:47], s34 offen lds
    ds_read_b64_tr_b16 v[36:37], v12 offset:8192
    ds_read_b64_tr_b16 v[38:39], v12 offset:8704
    ds_read_b64_tr_b16 v[48:49], v13 offset:24576
    ds_read_b64_tr_b16 v[50:51], v13 offset:25088
    s_waitcnt lgkmcnt(8)
    v_mfma_f32_32x32x16_bf16 v[16:31], v[40:43], v[52:55], v[16:31]
    s_add_u32 m0, s33, 88064
    s_add_u32 s34, s31, 1622016
    buffer_load_dwordx4 v3, s[44:47], s34 offen lds
    s_add_u32 m0, s33, 89088
    s_add_u32 s34, s31, 1646592
    buffer_load_dwordx4 v3, s[44:47], s34 offen lds
    ds_read_b64_tr_b16 v[40:41], v12 offset:10240
    ds_read_b64_tr_b16 v[42:43], v12 offset:10752
    ds_read_b64_tr_b16 v[52:53], v13 offset:26624
    ds_read_b64_tr_b16 v[54:55], v13 offset:27136
    s_waitcnt lgkmcnt(8)
    v_mfma_f32_32x32x16_bf16 v[16:31], v[32:35], v[44:47], v[16:31]
    s_add_u32 m0, s33, 102400
    s_add_u32 s34, s32, 655360
    buffer_load_dwordx4 v4, s[40:43], s34 offen lds
    s_add_u32 m0, s33, 103424
    s_add_u32 s34, s32, 665600
    buffer_load_dwordx4 v4, s[40:43], s34 offen lds
    ds_read_b64_tr_b16 v[32:33], v12 offset:12288
    ds_read_b64_tr_b16 v[34:35], v12 offset:12800
    ds_read_b64_tr_b16 v[44:45], v13 offset:28672
    ds_read_b64_tr_b16 v[46:47], v13 offset:29184
    s_waitcnt lgkmcnt(8)
    v_mfma_f32_32x32x16_bf16 v[16:31], v[36:39], v[48:51], v[16:31]
    s_add_u32 m0, s33, 104448
    s_add_u32 s34, s32, 675840
    buffer_load_dwordx4 v4, s[40:43], s34 offen lds
    s_add_u32 m0, s33, 105472
    s_add_u32 s34, s32, 686080
    buffer_load_dwordx4 v4, s[40:43], s34 offen lds
    ds_read_b64_tr_b16 v[36:37], v12 offset:14336
    ds_read_b64_tr_b16 v[38:39], v12 offset:14848
    ds_read_b64_tr_b16 v[48:49], v13 offset:30720
    ds_read_b64_tr_b16 v[50:51], v13 offset:31232
    s_waitcnt lgkmcnt(8)
    v_mfma_f32_32x32x16_bf16 v[16:31], v[40:43], v[52:55], v[16:31]
    s_waitcnt lgkmcnt(4)
    v_mfma_f32_32x32x16_bf16 v[16:31], v[32:35], v[44:47], v[16:31]
    s_waitcnt lgkmcnt(0)
    v_mfma_f32_32x32x16_bf16 v[16:31], v[36:39], v[48:51], v[16:31]
    s_waitcnt vmcnt(12)
    s_barrier
    ds_read_b64_tr_b16 v[32:33], v6 offset:0
    ds_read_b64_tr_b16 v[34:35], v6 offset:512
    ds_read_b64_tr_b16 v[44:45], v7 offset:16384
    ds_read_b64_tr_b16 v[46:47], v7 offset:16896
    ds_read_b64_tr_b16 v[36:37], v6 offset:2048
    ds_read_b64_tr_b16 v[38:39], v6 offset:2560
    ds_read_b64_tr_b16 v[48:49], v7 offset:18432
    ds_read_b64_tr_b16 v[50:51], v7 offset:18944
    s_add_u32 m0, s58, 26624
    s_add_u32 s34, s58, 24576
    buffer_load_dwordx4 v8, s[8:11], s34 offen lds
    s_add_u32 m0, s57, 31744
    s_add_u32 s34, s59, 1536
    buffer_load_dwordx4 v5, s[16:19], s34 offen lds
    ds_read_b64_tr_b16 v[40:41], v6 offset:4096
    ds_read_b64_tr_b16 v[42:43], v6 offset:4608
    ds_read_b64_tr_b16 v[52:53], v7 offset:20480
    ds_read_b64_tr_b16 v[54:55], v7 offset:20992
    s_waitcnt lgkmcnt(8)
    v_mfma_f32_32x32x16_bf16 v[16:31], v[32:35], v[44:47], v[16:31]
    s_add_u32 m0, s57, 32768
    s_add_u32 s34, s59, 1568
    buffer_load_dwordx4 v5, s[16:19], s34 offen lds
    s_mov_b32 m0, 30720
    s_mov_b32 s34, 6144
    s_mov_b64 exec, s[62:63]
    buffer_load_dwordx4 v9, s[12:15], s34 offen lds
    s_mov_b64 exec, -1
    ds_read_b64_tr_b16 v[32:33], v6 offset:6144
    ds_read_b64_tr_b16 v[34:35], v6 offset:6656
    ds_read_b64_tr_b16 v[44:45], v7 offset:22528
    ds_read_b64_tr_b16 v[46:47], v7 offset:23040
    s_waitcnt lgkmcnt(8)
    v_mfma_f32_32x32x16_bf16 v[16:31], v[36:39], v[48:51], v[16:31]
    s_add_u32 m0, s33, 118784
    s_add_u32 s34, s31, 1966080
    buffer_load_dwordx4 v3, s[44:47], s34 offen lds
    s_add_u32 m0, s33, 119808
    s_add_u32 s34, s31, 1990656
    buffer_load_dwordx4 v3, s[44:47], s34 offen lds
    ds_read_b64_tr_b16 v[36:37], v6 offset:8192
    ds_read_b64_tr_b16 v[38:39], v6 offset:8704
    ds_read_b64_tr_b16 v[48:49], v7 offset:24576
    ds_read_b64_tr_b16 v[50:51], v7 offset:25088
    s_waitcnt lgkmcnt(8)
    v_mfma_f32_32x32x16_bf16 v[16:31], v[40:43], v[52:55], v[16:31]
    s_add_u32 m0, s33, 120832
    s_add_u32 s34, s31, 2015232
    buffer_load_dwordx4 v3, s[44:47], s34 offen lds
    s_add_u32 m0, s33, 121856
    s_add_u32 s34, s31, 2039808
    buffer_load_dwordx4 v3, s[44:47], s34 offen lds
    ds_read_b64_tr_b16 v[40:41], v6 offset:10240
    ds_read_b64_tr_b16 v[42:43], v6 offset:10752
    ds_read_b64_tr_b16 v[52:53], v7 offset:26624
    ds_read_b64_tr_b16 v[54:55], v7 offset:27136
    s_waitcnt lgkmcnt(8)
    v_mfma_f32_32x32x16_bf16 v[16:31], v[32:35], v[44:47], v[16:31]
    s_add_u32 m0, s33, 135168
    s_add_u32 s34, s32, 819200
    buffer_load_dwordx4 v4, s[40:43], s34 offen lds
    s_add_u32 m0, s33, 136192
    s_add_u32 s34, s32, 829440
    buffer_load_dwordx4 v4, s[40:43], s34 offen lds
    ds_read_b64_tr_b16 v[32:33], v6 offset:12288
    ds_read_b64_tr_b16 v[34:35], v6 offset:12800
    ds_read_b64_tr_b16 v[44:45], v7 offset:28672
    ds_read_b64_tr_b16 v[46:47], v7 offset:29184
    s_waitcnt lgkmcnt(8)
    v_mfma_f32_32x32x16_bf16 v[16:31], v[36:39], v[48:51], v[16:31]
    s_add_u32 m0, s33, 137216
    s_add_u32 s34, s32, 839680
    buffer_load_dwordx4 v4, s[40:43], s34 offen lds
    s_add_u32 m0, s33, 138240
    s_add_u32 s34, s32, 849920
    buffer_load_dwordx4 v4, s[40:43], s34 offen lds
    ds_read_b64_tr_b16 v[36:37], v6 offset:14336
    ds_read_b64_tr_b16 v[38:39], v6 offset:14848
    ds_read_b64_tr_b16 v[48:49], v7 offset:30720
    ds_read_b64_tr_b16 v[50:51], v7 offset:31232
    s_waitcnt lgkmcnt(8)
    v_mfma_f32_32x32x16_bf16 v[16:31], v[40:43], v[52:55], v[16:31]
    s_waitcnt lgkmcnt(4)
    v_mfma_f32_32x32x16_bf16 v[16:31], v[32:35], v[44:47], v[16:31]
    s_waitcnt lgkmcnt(0)
    v_mfma_f32_32x32x16_bf16 v[16:31], v[36:39], v[48:51], v[16:31]
    s_waitcnt vmcnt(12)
    s_barrier
    ds_read_b64_tr_b16 v[32:33], v6 offset:32768
    ds_read_b64_tr_b16 v[34:35], v6 offset:33280
    ds_read_b64_tr_b16 v[44:45], v7 offset:49152
    ds_read_b64_tr_b16 v[46:47], v7 offset:49664
    ds_read_b64_tr_b16 v[36:37], v6 offset:34816
    ds_read_b64_tr_b16 v[38:39], v6 offset:35328
    ds_read_b64_tr_b16 v[48:49], v7 offset:51200
    ds_read_b64_tr_b16 v[50:51], v7 offset:51712
    s_add_u32 m0, s58, 39936
    s_add_u32 s34, s58, 28672
    buffer_load_dwordx4 v8, s[8:11], s34 offen lds
    s_add_u32 m0, s57, 45056
    s_add_u32 s34, s59, 1792
    buffer_load_dwordx4 v5, s[16:19], s34 offen lds
    ds_read_b64_tr_b16 v[40:41], v6 offset:36864
    ds_read_b64_tr_b16 v[42:43], v6 offset:37376
    ds_read_b64_tr_b16 v[52:53], v7 offset:53248
    ds_read_b64_tr_b16 v[54:55], v7 offset:53760
    s_waitcnt lgkmcnt(8)
    v_mfma_f32_32x32x16_bf16 v[16:31], v[32:35], v[44:47], v[16:31]
    s_add_u32 m0, s57, 46080
    s_add_u32 s34, s59, 1824
    buffer_load_dwordx4 v5, s[16:19], s34 offen lds
    s_mov_b32 m0, 44032
    s_mov_b32 s34, 7168
    s_mov_b64 exec, s[62:63]
    buffer_load_dwordx4 v9, s[12:15], s34 offen lds
    s_mov_b64 exec, -1
    ds_read_b64_tr_b16 v[32:33], v6 offset:38912
    ds_read_b64_tr_b16 v[34:35], v6 offset:39424
    ds_read_b64_tr_b16 v[44:45], v7 offset:55296
    ds_read_b64_tr_b16 v[46:47], v7 offset:55808
    s_waitcnt lgkmcnt(8)
    v_mfma_f32_32x32x16_bf16 v[16:31], v[36:39], v[48:51], v[16:31]
    s_add_u32 m0, s33, 53248
    s_add_u32 s34, s31, 2359296
    buffer_load_dwordx4 v3, s[44:47], s34 offen lds
    s_add_u32 m0, s33, 54272
    s_add_u32 s34, s31, 2383872
    buffer_load_dwordx4 v3, s[44:47], s34 offen lds
    ds_read_b64_tr_b16 v[36:37], v6 offset:40960
    ds_read_b64_tr_b16 v[38:39], v6 offset:41472
    ds_read_b64_tr_b16 v[48:49], v7 offset:57344
    ds_read_b64_tr_b16 v[50:51], v7 offset:57856
    s_waitcnt lgkmcnt(8)
    v_mfma_f32_32x32x16_bf16 v[16:31], v[40:43], v[52:55], v[16:31]
    s_add_u32 m0, s33, 55296
    s_add_u32 s34, s31, 2408448
    buffer_load_dwordx4 v3, s[44:47], s34 offen lds
    s_add_u32 m0, s33, 56320
    s_add_u32 s34, s31, 2433024
    buffer_load_dwordx4 v3, s[44:47], s34 offen lds
    ds_read_b64_tr_b16 v[40:41], v6 offset:43008
    ds_read_b64_tr_b16 v[42:43], v6 offset:43520
    ds_read_b64_tr_b16 v[52:53], v7 offset:59392
    ds_read_b64_tr_b16 v[54:55], v7 offset:59904
    s_waitcnt lgkmcnt(8)
    v_mfma_f32_32x32x16_bf16 v[16:31], v[32:35], v[44:47], v[16:31]
    s_add_u32 m0, s33, 69632
    s_add_u32 s34, s32, 983040
    buffer_load_dwordx4 v4, s[40:43], s34 offen lds
    s_add_u32 m0, s33, 70656
    s_add_u32 s34, s32, 993280
    buffer_load_dwordx4 v4, s[40:43], s34 offen lds
    ds_read_b64_tr_b16 v[32:33], v6 offset:45056
    ds_read_b64_tr_b16 v[34:35], v6 offset:45568
    ds_read_b64_tr_b16 v[44:45], v7 offset:61440
    ds_read_b64_tr_b16 v[46:47], v7 offset:61952
    s_waitcnt lgkmcnt(8)
    v_mfma_f32_32x32x16_bf16 v[16:31], v[36:39], v[48:51], v[16:31]
    s_add_u32 m0, s33, 71680
    s_add_u32 s34, s32, 1003520
    buffer_load_dwordx4 v4, s[40:43], s34 offen lds
    s_add_u32 m0, s33, 72704
    s_add_u32 s34, s32, 1013760
    buffer_load_dwordx4 v4, s[40:43], s34 offen lds
    ds_read_b64_tr_b16 v[36:37], v6 offset:47104
    ds_read_b64_tr_b16 v[38:39], v6 offset:47616
    ds_read_b64_tr_b16 v[48:49], v7 offset:63488
    ds_read_b64_tr_b16 v[50:51], v7 offset:64000
    s_waitcnt lgkmcnt(8)
    v_mfma_f32_32x32x16_bf16 v[16:31], v[40:43], v[52:55], v[16:31]
    s_waitcnt lgkmcnt(4)
    v_mfma_f32_32x32x16_bf16 v[16:31], v[32:35], v[44:47], v[16:31]
    s_waitcnt lgkmcnt(0)
    v_mfma_f32_32x32x16_bf16 v[16:31], v[36:39], v[48:51], v[16:31]
    s_waitcnt vmcnt(12)
    s_barrier
    ds_read_b64_tr_b16 v[32:33], v12 offset:0
    ds_read_b64_tr_b16 v[34:35], v12 offset:512
    ds_read_b64_tr_b16 v[44:45], v13 offset:16384
    ds_read_b64_tr_b16 v[46:47], v13 offset:16896
    ds_read_b64_tr_b16 v[36:37], v12 offset:2048
    ds_read_b64_tr_b16 v[38:39], v12 offset:2560
    ds_read_b64_tr_b16 v[48:49], v13 offset:18432
    ds_read_b64_tr_b16 v[50:51], v13 offset:18944
    s_add_u32 m0, s58, 0
    s_add_u32 s34, s58, 32768
    buffer_load_dwordx4 v8, s[8:11], s34 offen lds
    s_add_u32 m0, s57, 5120
    s_add_u32 s34, s59, 2048
    buffer_load_dwordx4 v5, s[16:19], s34 offen lds
    ds_read_b64_tr_b16 v[40:41], v12 offset:4096
    ds_read_b64_tr_b16 v[42:43], v12 offset:4608
    ds_read_b64_tr_b16 v[52:53], v13 offset:20480
    ds_read_b64_tr_b16 v[54:55], v13 offset:20992
    s_waitcnt lgkmcnt(8)
    v_mfma_f32_32x32x16_bf16 v[16:31], v[32:35], v[44:47], v[16:31]
    s_add_u32 m0, s57, 6144
    s_add_u32 s34, s59, 2080
    buffer_load_dwordx4 v5, s[16:19], s34 offen lds
    s_mov_b32 m0, 4096
    s_mov_b32 s34, 8192
    s_mov_b64 exec, s[62:63]
    buffer_load_dwordx4 v9, s[12:15], s34 offen lds
    s_mov_b64 exec, -1
    ds_read_b64_tr_b16 v[32:33], v12 offset:6144
    ds_read_b64_tr_b16 v[34:35], v12 offset:6656
    ds_read_b64_tr_b16 v[44:45], v13 offset:22528
    ds_read_b64_tr_b16 v[46:47], v13 offset:23040
    s_waitcnt lgkmcnt(8)
    v_mfma_f32_32x32x16_bf16 v[16:31], v[36:39], v[48:51], v[16:31]
    s_add_u32 m0, s33, 86016
    s_add_u32 s34, s31, 2752512
    buffer_load_dwordx4 v3, s[44:47], s34 offen lds
    s_add_u32 m0, s33, 87040
    s_add_u32 s34, s31, 2777088
    buffer_load_dwordx4 v3, s[44:47], s34 offen lds
    ds_read_b64_tr_b16 v[36:37], v12 offset:8192
    ds_read_b64_tr_b16 v[38:39], v12 offset:8704
    ds_read_b64_tr_b16 v[48:49], v13 offset:24576
    ds_read_b64_tr_b16 v[50:51], v13 offset:25088
    s_waitcnt lgkmcnt(8)
    v_mfma_f32_32x32x16_bf16 v[16:31], v[40:43], v[52:55], v[16:31]
    s_add_u32 m0, s33, 88064
    s_add_u32 s34, s31, 2801664
    buffer_load_dwordx4 v3, s[44:47], s34 offen lds
    s_add_u32 m0, s33, 89088
    s_add_u32 s34, s31, 2826240
    buffer_load_dwordx4 v3, s[44:47], s34 offen lds
    ds_read_b64_tr_b16 v[40:41], v12 offset:10240
    ds_read_b64_tr_b16 v[42:43], v12 offset:10752
    ds_read_b64_tr_b16 v[52:53], v13 offset:26624
    ds_read_b64_tr_b16 v[54:55], v13 offset:27136
    s_waitcnt lgkmcnt(8)
    v_mfma_f32_32x32x16_bf16 v[16:31], v[32:35], v[44:47], v[16:31]
    s_add_u32 m0, s33, 102400
    s_add_u32 s34, s32, 1146880
    buffer_load_dwordx4 v4, s[40:43], s34 offen lds
    s_add_u32 m0, s33, 103424
    s_add_u32 s34, s32, 1157120
    buffer_load_dwordx4 v4, s[40:43], s34 offen lds
    ds_read_b64_tr_b16 v[32:33], v12 offset:12288
    ds_read_b64_tr_b16 v[34:35], v12 offset:12800
    ds_read_b64_tr_b16 v[44:45], v13 offset:28672
    ds_read_b64_tr_b16 v[46:47], v13 offset:29184
    s_waitcnt lgkmcnt(8)
    v_mfma_f32_32x32x16_bf16 v[16:31], v[36:39], v[48:51], v[16:31]
    s_add_u32 m0, s33, 104448
    s_add_u32 s34, s32, 1167360
    buffer_load_dwordx4 v4, s[40:43], s34 offen lds
    s_add_u32 m0, s33, 105472
    s_add_u32 s34, s32, 1177600
    buffer_load_dwordx4 v4, s[40:43], s34 offen lds
    ds_read_b64_tr_b16 v[36:37], v12 offset:14336
    ds_read_b64_tr_b16 v[38:39], v12 offset:14848
    ds_read_b64_tr_b16 v[48:49], v13 offset:30720
    ds_read_b64_tr_b16 v[50:51], v13 offset:31232
    s_waitcnt lgkmcnt(8)
    v_mfma_f32_32x32x16_bf16 v[16:31], v[40:43], v[52:55], v[16:31]
    s_waitcnt lgkmcnt(4)
    v_mfma_f32_32x32x16_bf16 v[16:31], v[32:35], v[44:47], v[16:31]
    s_waitcnt lgkmcnt(0)
    v_mfma_f32_32x32x16_bf16 v[16:31], v[36:39], v[48:51], v[16:31]
    s_waitcnt vmcnt(12)
    s_barrier
    ds_read_b64_tr_b16 v[32:33], v6 offset:0
    ds_read_b64_tr_b16 v[34:35], v6 offset:512
    ds_read_b64_tr_b16 v[44:45], v7 offset:16384
    ds_read_b64_tr_b16 v[46:47], v7 offset:16896
    ds_read_b64_tr_b16 v[36:37], v6 offset:2048
    ds_read_b64_tr_b16 v[38:39], v6 offset:2560
    ds_read_b64_tr_b16 v[48:49], v7 offset:18432
    ds_read_b64_tr_b16 v[50:51], v7 offset:18944
    s_mov_b32 s72, s66
    s_and_b32 s73, s67, 0xffff
    s_mov_b32 s74, 6291456
    s_mov_b32 s75, 0x00020000
    s_mov_b32 s76, s68
    s_and_b32 s77, s69, 0xffff
    s_mov_b32 s78, 819200
    s_mov_b32 s79, 0x00020000
    s_lshl_b32 s34, s2, 2
    s_add_u32 s34, s34, s3
    s_mul_i32 s39, s34, 6144
    v_lshlrev_b32 v15, 7, v2
    buffer_load_dword v122, v15, s[72:75], s39 offen
    s_lshl_b32 s39, s34, 13
    buffer_load_dword v121, v15, s[76:79], s39 offen
    ds_read_b64_tr_b16 v[40:41], v6 offset:4096
    ds_read_b64_tr_b16 v[42:43], v6 offset:4608
    ds_read_b64_tr_b16 v[52:53], v7 offset:20480
    ds_read_b64_tr_b16 v[54:55], v7 offset:20992
    s_waitcnt lgkmcnt(8)
    v_mfma_f32_32x32x16_bf16 v[16:31], v[32:35], v[44:47], v[16:31]
    s_add_u32 m0, s58, 13312
    s_add_u32 s34, s58, 36864
    buffer_load_dwordx4 v8, s[8:11], s34 offen lds
    s_add_u32 m0, s57, 18432
    s_add_u32 s34, s59, 2304
    buffer_load_dwordx4 v5, s[16:19], s34 offen lds
    ds_read_b64_tr_b16 v[32:33], v6 offset:6144
    ds_read_b64_tr_b16 v[34:35], v6 offset:6656
    ds_read_b64_tr_b16 v[44:45], v7 offset:22528
    ds_read_b64_tr_b16 v[46:47], v7 offset:23040
    s_waitcnt lgkmcnt(8)
    v_mfma_f32_32x32x16_bf16 v[16:31], v[36:39], v[48:51], v[16:31]
    s_add_u32 m0, s57, 19456
    s_add_u32 s34, s59, 2336
    buffer_load_dwordx4 v5, s[16:19], s34 offen lds
    s_mov_b32 m0, 17408
    s_mov_b32 s34, 9216
    s_mov_b64 exec, s[62:63]
    buffer_load_dwordx4 v9, s[12:15], s34 offen lds
    s_mov_b64 exec, -1
    ds_read_b64_tr_b16 v[36:37], v6 offset:8192
    ds_read_b64_tr_b16 v[38:39], v6 offset:8704
    ds_read_b64_tr_b16 v[48:49], v7 offset:24576
    ds_read_b64_tr_b16 v[50:51], v7 offset:25088
    s_waitcnt lgkmcnt(8)
    v_mfma_f32_32x32x16_bf16 v[16:31], v[40:43], v[52:55], v[16:31]
    s_add_u32 m0, s33, 118784
    s_add_u32 s34, s31, 3145728
    buffer_load_dwordx4 v3, s[44:47], s34 offen lds
    s_add_u32 m0, s33, 119808
    s_add_u32 s34, s31, 3170304
    buffer_load_dwordx4 v3, s[44:47], s34 offen lds
    ds_read_b64_tr_b16 v[40:41], v6 offset:10240
    ds_read_b64_tr_b16 v[42:43], v6 offset:10752
    ds_read_b64_tr_b16 v[52:53], v7 offset:26624
    ds_read_b64_tr_b16 v[54:55], v7 offset:27136
    s_waitcnt lgkmcnt(8)
    v_mfma_f32_32x32x16_bf16 v[16:31], v[32:35], v[44:47], v[16:31]
    s_add_u32 m0, s33, 120832
    s_add_u32 s34, s31, 3194880
    buffer_load_dwordx4 v3, s[44:47], s34 offen lds
    s_add_u32 m0, s33, 121856
    s_add_u32 s34, s31, 3219456
    buffer_load_dwordx4 v3, s[44:47], s34 offen lds
    ds_read_b64_tr_b16 v[32:33], v6 offset:12288
    ds_read_b64_tr_b16 v[34:35], v6 offset:12800
    ds_read_b64_tr_b16 v[44:45], v7 offset:28672
    ds_read_b64_tr_b16 v[46:47], v7 offset:29184
    s_waitcnt lgkmcnt(8)
    v_mfma_f32_32x32x16_bf16 v[16:31], v[36:39], v[48:51], v[16:31]
    s_add_u32 m0, s33, 135168
    s_add_u32 s34, s32, 1310720
    buffer_load_dwordx4 v4, s[40:43], s34 offen lds
    s_add_u32 m0, s33, 136192
    s_add_u32 s34, s32, 1320960
    buffer_load_dwordx4 v4, s[40:43], s34 offen lds
    ds_read_b64_tr_b16 v[36:37], v6 offset:14336
    ds_read_b64_tr_b16 v[38:39], v6 offset:14848
    ds_read_b64_tr_b16 v[48:49], v7 offset:30720
    ds_read_b64_tr_b16 v[50:51], v7 offset:31232
    s_waitcnt lgkmcnt(8)
    v_mfma_f32_32x32x16_bf16 v[16:31], v[40:43], v[52:55], v[16:31]
    s_add_u32 m0, s33, 137216
    s_add_u32 s34, s32, 1331200
    buffer_load_dwordx4 v4, s[40:43], s34 offen lds
    s_add_u32 m0, s33, 138240
    s_add_u32 s34, s32, 1341440
    buffer_load_dwordx4 v4, s[40:43], s34 offen lds
    s_waitcnt lgkmcnt(4)
    v_mfma_f32_32x32x16_bf16 v[16:31], v[32:35], v[44:47], v[16:31]
    s_waitcnt lgkmcnt(0)
    v_mfma_f32_32x32x16_bf16 v[16:31], v[36:39], v[48:51], v[16:31]
    s_waitcnt vmcnt(0)
    s_barrier
    ds_read_b64_tr_b16 v[32:33], v6 offset:32768
    ds_read_b64_tr_b16 v[34:35], v6 offset:33280
    ds_read_b64_tr_b16 v[44:45], v7 offset:49152
    ds_read_b64_tr_b16 v[46:47], v7 offset:49664
    ds_read_b64_tr_b16 v[36:37], v6 offset:34816
    ds_read_b64_tr_b16 v[38:39], v6 offset:35328
    ds_read_b64_tr_b16 v[48:49], v7 offset:51200
    ds_read_b64_tr_b16 v[50:51], v7 offset:51712
    s_add_u32 m0, s58, 26624
    s_add_u32 s34, s58, 40960
    buffer_load_dwordx4 v8, s[8:11], s34 offen lds
    s_add_u32 m0, s57, 31744
    s_add_u32 s34, s59, 2560
    buffer_load_dwordx4 v5, s[16:19], s34 offen lds
    ds_read_b64_tr_b16 v[40:41], v6 offset:36864
    ds_read_b64_tr_b16 v[42:43], v6 offset:37376
    ds_read_b64_tr_b16 v[52:53], v7 offset:53248
    ds_read_b64_tr_b16 v[54:55], v7 offset:53760
    s_waitcnt lgkmcnt(8)
    v_mfma_f32_32x32x16_bf16 v[16:31], v[32:35], v[44:47], v[16:31]
    s_add_u32 m0, s57, 32768
    s_add_u32 s34, s59, 2592
    buffer_load_dwordx4 v5, s[16:19], s34 offen lds
    s_mov_b32 m0, 30720
    s_mov_b32 s34, 10240
    s_mov_b64 exec, s[62:63]
    buffer_load_dwordx4 v9, s[12:15], s34 offen lds
    s_mov_b64 exec, -1
    ds_read_b64_tr_b16 v[32:33], v6 offset:38912
    ds_read_b64_tr_b16 v[34:35], v6 offset:39424
    ds_read_b64_tr_b16 v[44:45], v7 offset:55296
    ds_read_b64_tr_b16 v[46:47], v7 offset:55808
    s_waitcnt lgkmcnt(8)
    v_mfma_f32_32x32x16_bf16 v[16:31], v[36:39], v[48:51], v[16:31]
    s_add_u32 m0, s33, 53248
    s_add_u32 s34, s31, 3538944
    buffer_load_dwordx4 v3, s[44:47], s34 offen lds
    s_add_u32 m0, s33, 54272
    s_add_u32 s34, s31, 3563520
    buffer_load_dwordx4 v3, s[44:47], s34 offen lds
    ds_read_b64_tr_b16 v[36:37], v6 offset:40960
    ds_read_b64_tr_b16 v[38:39], v6 offset:41472
    ds_read_b64_tr_b16 v[48:49], v7 offset:57344
    ds_read_b64_tr_b16 v[50:51], v7 offset:57856
    s_waitcnt lgkmcnt(8)
    v_mfma_f32_32x32x16_bf16 v[16:31], v[40:43], v[52:55], v[16:31]
    s_add_u32 m0, s33, 55296
    s_add_u32 s34, s31, 3588096
    buffer_load_dwordx4 v3, s[44:47], s34 offen lds
    s_add_u32 m0, s33, 56320
    s_add_u32 s34, s31, 3612672
    buffer_load_dwordx4 v3, s[44:47], s34 offen lds
    ds_read_b64_tr_b16 v[40:41], v6 offset:43008
    ds_read_b64_tr_b16 v[42:43], v6 offset:43520
    ds_read_b64_tr_b16 v[52:53], v7 offset:59392
    ds_read_b64_tr_b16 v[54:55], v7 offset:59904
    s_waitcnt lgkmcnt(8)
    v_mfma_f32_32x32x16_bf16 v[16:31], v[32:35], v[44:47], v[16:31]
    s_add_u32 m0, s33, 69632
    s_add_u32 s34, s32, 1474560
    buffer_load_dwordx4 v4, s[40:43], s34 offen lds
    s_add_u32 m0, s33, 70656
    s_add_u32 s34, s32, 1484800
    buffer_load_dwordx4 v4, s[40:43], s34 offen lds
    ds_read_b64_tr_b16 v[32:33], v6 offset:45056
    ds_read_b64_tr_b16 v[34:35], v6 offset:45568
    ds_read_b64_tr_b16 v[44:45], v7 offset:61440
    ds_read_b64_tr_b16 v[46:47], v7 offset:61952
    s_waitcnt lgkmcnt(8)
    v_mfma_f32_32x32x16_bf16 v[16:31], v[36:39], v[48:51], v[16:31]
    s_add_u32 m0, s33, 71680
    s_add_u32 s34, s32, 1495040
    buffer_load_dwordx4 v4, s[40:43], s34 offen lds
    s_add_u32 m0, s33, 72704
    s_add_u32 s34, s32, 1505280
    buffer_load_dwordx4 v4, s[40:43], s34 offen lds
    ds_read_b64_tr_b16 v[36:37], v6 offset:47104
    ds_read_b64_tr_b16 v[38:39], v6 offset:47616
    ds_read_b64_tr_b16 v[48:49], v7 offset:63488
    ds_read_b64_tr_b16 v[50:51], v7 offset:64000
    s_waitcnt lgkmcnt(8)
    v_mfma_f32_32x32x16_bf16 v[16:31], v[40:43], v[52:55], v[16:31]
    s_waitcnt lgkmcnt(4)
    v_mfma_f32_32x32x16_bf16 v[16:31], v[32:35], v[44:47], v[16:31]
    s_waitcnt lgkmcnt(0)
    v_mfma_f32_32x32x16_bf16 v[16:31], v[36:39], v[48:51], v[16:31]
    ds_read_b64_tr_b16 v[32:33], v12 offset:0
    ds_read_b64_tr_b16 v[34:35], v12 offset:512
    ds_read_b64_tr_b16 v[44:45], v13 offset:16384
    ds_read_b64_tr_b16 v[46:47], v13 offset:16896
    ds_read_b64_tr_b16 v[36:37], v12 offset:2048
    ds_read_b64_tr_b16 v[38:39], v12 offset:2560
    ds_read_b64_tr_b16 v[48:49], v13 offset:18432
    ds_read_b64_tr_b16 v[50:51], v13 offset:18944
    ds_read_b64_tr_b16 v[40:41], v12 offset:4096
    ds_read_b64_tr_b16 v[42:43], v12 offset:4608
    ds_read_b64_tr_b16 v[52:53], v13 offset:20480
    ds_read_b64_tr_b16 v[54:55], v13 offset:20992
    s_waitcnt lgkmcnt(8)
    v_mfma_f32_32x32x16_bf16 v[16:31], v[32:35], v[44:47], v[16:31]
    ds_read_b64_tr_b16 v[32:33], v12 offset:6144
    ds_read_b64_tr_b16 v[34:35], v12 offset:6656
    ds_read_b64_tr_b16 v[44:45], v13 offset:22528
    ds_read_b64_tr_b16 v[46:47], v13 offset:23040
    s_waitcnt lgkmcnt(8)
    v_mfma_f32_32x32x16_bf16 v[16:31], v[36:39], v[48:51], v[16:31]
    ds_read_b64_tr_b16 v[36:37], v12 offset:8192
    ds_read_b64_tr_b16 v[38:39], v12 offset:8704
    ds_read_b64_tr_b16 v[48:49], v13 offset:24576
    ds_read_b64_tr_b16 v[50:51], v13 offset:25088
    s_waitcnt lgkmcnt(8)
    v_mfma_f32_32x32x16_bf16 v[16:31], v[40:43], v[52:55], v[16:31]
    ds_read_b64_tr_b16 v[40:41], v12 offset:10240
    ds_read_b64_tr_b16 v[42:43], v12 offset:10752
    ds_read_b64_tr_b16 v[52:53], v13 offset:26624
    ds_read_b64_tr_b16 v[54:55], v13 offset:27136
    s_waitcnt lgkmcnt(8)
    v_mfma_f32_32x32x16_bf16 v[16:31], v[32:35], v[44:47], v[16:31]
    ds_read_b64_tr_b16 v[32:33], v12 offset:12288
    ds_read_b64_tr_b16 v[34:35], v12 offset:12800
    ds_read_b64_tr_b16 v[44:45], v13 offset:28672
    ds_read_b64_tr_b16 v[46:47], v13 offset:29184
    s_waitcnt lgkmcnt(8)
    v_mfma_f32_32x32x16_bf16 v[16:31], v[36:39], v[48:51], v[16:31]
    ds_read_b64_tr_b16 v[36:37], v12 offset:14336
    ds_read_b64_tr_b16 v[38:39], v12 offset:14848
    ds_read_b64_tr_b16 v[48:49], v13 offset:30720
    ds_read_b64_tr_b16 v[50:51], v13 offset:31232
    s_waitcnt lgkmcnt(8)
    v_mfma_f32_32x32x16_bf16 v[16:31], v[40:43], v[52:55], v[16:31]
    s_waitcnt lgkmcnt(4)
    v_mfma_f32_32x32x16_bf16 v[16:31], v[32:35], v[44:47], v[16:31]
    s_waitcnt lgkmcnt(0)
    v_mfma_f32_32x32x16_bf16 v[16:31], v[36:39], v[48:51], v[16:31]
    s_waitcnt vmcnt(0)
    s_barrier
    ds_read_b64_tr_b16 v[32:33], v6 offset:0
    ds_read_b64_tr_b16 v[34:35], v6 offset:512
    ds_read_b64_tr_b16 v[44:45], v7 offset:16384
    ds_read_b64_tr_b16 v[46:47], v7 offset:16896
    ds_read_b64_tr_b16 v[36:37], v6 offset:2048
    ds_read_b64_tr_b16 v[38:39], v6 offset:2560
    ds_read_b64_tr_b16 v[48:49], v7 offset:18432
    ds_read_b64_tr_b16 v[50:51], v7 offset:18944
    s_add_u32 m0, s58, 39936
    s_add_u32 s34, s58, 45056
    buffer_load_dwordx4 v8, s[8:11], s34 offen lds
    s_add_u32 m0, s57, 45056
    s_add_u32 s34, s59, 2816
    buffer_load_dwordx4 v5, s[16:19], s34 offen lds
    ds_read_b64_tr_b16 v[40:41], v6 offset:4096
    ds_read_b64_tr_b16 v[42:43], v6 offset:4608
    ds_read_b64_tr_b16 v[52:53], v7 offset:20480
    ds_read_b64_tr_b16 v[54:55], v7 offset:20992
    s_waitcnt lgkmcnt(8)
    v_mfma_f32_32x32x16_bf16 v[16:31], v[32:35], v[44:47], v[16:31]
    s_add_u32 m0, s57, 46080
    s_add_u32 s34, s59, 2848
    buffer_load_dwordx4 v5, s[16:19], s34 offen lds
    s_mov_b32 m0, 44032
    s_mov_b32 s34, 11264
    s_mov_b64 exec, s[62:63]
    buffer_load_dwordx4 v9, s[12:15], s34 offen lds
    s_mov_b64 exec, -1
    ds_read_b64_tr_b16 v[32:33], v6 offset:6144
    ds_read_b64_tr_b16 v[34:35], v6 offset:6656
    ds_read_b64_tr_b16 v[44:45], v7 offset:22528
    ds_read_b64_tr_b16 v[46:47], v7 offset:23040
    s_waitcnt lgkmcnt(8)
    v_mfma_f32_32x32x16_bf16 v[16:31], v[36:39], v[48:51], v[16:31]
    s_add_u32 m0, s33, 86016
    s_add_u32 s34, s31, 3932160
    buffer_load_dwordx4 v3, s[44:47], s34 offen lds
    s_add_u32 m0, s33, 87040
    s_add_u32 s34, s31, 3956736
    buffer_load_dwordx4 v3, s[44:47], s34 offen lds
    ds_read_b64_tr_b16 v[36:37], v6 offset:8192
    ds_read_b64_tr_b16 v[38:39], v6 offset:8704
    ds_read_b64_tr_b16 v[48:49], v7 offset:24576
    ds_read_b64_tr_b16 v[50:51], v7 offset:25088
    s_waitcnt lgkmcnt(8)
    v_mfma_f32_32x32x16_bf16 v[16:31], v[40:43], v[52:55], v[16:31]
    s_add_u32 m0, s33, 88064
    s_add_u32 s34, s31, 3981312
    buffer_load_dwordx4 v3, s[44:47], s34 offen lds
    s_add_u32 m0, s33, 89088
    s_add_u32 s34, s31, 4005888
    buffer_load_dwordx4 v3, s[44:47], s34 offen lds
    ds_read_b64_tr_b16 v[40:41], v6 offset:10240
    ds_read_b64_tr_b16 v[42:43], v6 offset:10752
    ds_read_b64_tr_b16 v[52:53], v7 offset:26624
    ds_read_b64_tr_b16 v[54:55], v7 offset:27136
    s_waitcnt lgkmcnt(8)
    v_mfma_f32_32x32x16_bf16 v[16:31], v[32:35], v[44:47], v[16:31]
    s_add_u32 m0, s33, 102400
    s_add_u32 s34, s32, 1638400
    buffer_load_dwordx4 v4, s[40:43], s34 offen lds
    s_add_u32 m0, s33, 103424
    s_add_u32 s34, s32, 1648640
    buffer_load_dwordx4 v4, s[40:43], s34 offen lds
    ds_read_b64_tr_b16 v[32:33], v6 offset:12288
    ds_read_b64_tr_b16 v[34:35], v6 offset:12800
    ds_read_b64_tr_b16 v[44:45], v7 offset:28672
    ds_read_b64_tr_b16 v[46:47], v7 offset:29184
    s_waitcnt lgkmcnt(8)
    v_mfma_f32_32x32x16_bf16 v[16:31], v[36:39], v[48:51], v[16:31]
    s_add_u32 m0, s33, 104448
    s_add_u32 s34, s32, 1658880
    buffer_load_dwordx4 v4, s[40:43], s34 offen lds
    s_add_u32 m0, s33, 105472
    s_add_u32 s34, s32, 1669120
    buffer_load_dwordx4 v4, s[40:43], s34 offen lds
    ds_read_b64_tr_b16 v[36:37], v6 offset:14336
    ds_read_b64_tr_b16 v[38:39], v6 offset:14848
    ds_read_b64_tr_b16 v[48:49], v7 offset:30720
    ds_read_b64_tr_b16 v[50:51], v7 offset:31232
    s_waitcnt lgkmcnt(8)
    v_mfma_f32_32x32x16_bf16 v[16:31], v[40:43], v[52:55], v[16:31]
    s_add_u32 m0, s33, 118784
    s_add_u32 s34, s31, 4325376
    buffer_load_dwordx4 v3, s[44:47], s34 offen lds
    s_add_u32 m0, s33, 119808
    s_add_u32 s34, s31, 4349952
    buffer_load_dwordx4 v3, s[44:47], s34 offen lds
    s_waitcnt lgkmcnt(4)
    v_mfma_f32_32x32x16_bf16 v[16:31], v[32:35], v[44:47], v[16:31]
    s_add_u32 m0, s33, 120832
    s_add_u32 s34, s31, 4374528
    buffer_load_dwordx4 v3, s[44:47], s34 offen lds
    s_add_u32 m0, s33, 121856
    s_add_u32 s34, s31, 4399104
    buffer_load_dwordx4 v3, s[44:47], s34 offen lds
    s_waitcnt lgkmcnt(0)
    v_mfma_f32_32x32x16_bf16 v[16:31], v[36:39], v[48:51], v[16:31]
    s_add_u32 m0, s33, 135168
    s_add_u32 s34, s32, 1802240
    buffer_load_dwordx4 v4, s[40:43], s34 offen lds
    s_add_u32 m0, s33, 136192
    s_add_u32 s34, s32, 1812480
    buffer_load_dwordx4 v4, s[40:43], s34 offen lds
    s_add_u32 m0, s33, 137216
    s_add_u32 s34, s32, 1822720
    buffer_load_dwordx4 v4, s[40:43], s34 offen lds
    s_add_u32 m0, s33, 138240
    s_add_u32 s34, s32, 1832960
    buffer_load_dwordx4 v4, s[40:43], s34 offen lds
    s_waitcnt vmcnt(8)
    s_barrier
    ds_read_b64_tr_b16 v[32:33], v6 offset:32768
    ds_read_b64_tr_b16 v[34:35], v6 offset:33280
    ds_read_b64_tr_b16 v[44:45], v7 offset:49152
    ds_read_b64_tr_b16 v[46:47], v7 offset:49664
    ds_read_b64_tr_b16 v[36:37], v6 offset:34816
    ds_read_b64_tr_b16 v[38:39], v6 offset:35328
    ds_read_b64_tr_b16 v[48:49], v7 offset:51200
    ds_read_b64_tr_b16 v[50:51], v7 offset:51712
    s_add_u32 m0, s58, 0
    s_add_u32 s34, s58, 49152
    buffer_load_dwordx4 v8, s[8:11], s34 offen lds
    s_add_u32 m0, s57, 5120
    s_add_u32 s34, s59, 3072
    buffer_load_dwordx4 v5, s[16:19], s34 offen lds
    ds_read_b64_tr_b16 v[40:41], v6 offset:36864
    ds_read_b64_tr_b16 v[42:43], v6 offset:37376
    ds_read_b64_tr_b16 v[52:53], v7 offset:53248
    ds_read_b64_tr_b16 v[54:55], v7 offset:53760
    s_waitcnt lgkmcnt(8)
    v_mfma_f32_32x32x16_bf16 v[16:31], v[32:35], v[44:47], v[16:31]
    s_add_u32 m0, s57, 6144
    s_add_u32 s34, s59, 3104
    buffer_load_dwordx4 v5, s[16:19], s34 offen lds
    s_mov_b32 m0, 4096
    s_mov_b32 s34, 12288
    s_mov_b64 exec, s[62:63]
    buffer_load_dwordx4 v9, s[12:15], s34 offen lds
    s_mov_b64 exec, -1
    ds_read_b64_tr_b16 v[32:33], v6 offset:38912
    ds_read_b64_tr_b16 v[34:35], v6 offset:39424
    ds_read_b64_tr_b16 v[44:45], v7 offset:55296
    ds_read_b64_tr_b16 v[46:47], v7 offset:55808
    s_waitcnt lgkmcnt(8)
    v_mfma_f32_32x32x16_bf16 v[16:31], v[36:39], v[48:51], v[16:31]
    s_add_u32 m0, s33, 53248
    s_add_u32 s34, s31, 4718592
    buffer_load_dwordx4 v3, s[44:47], s34 offen lds
    s_add_u32 m0, s33, 54272
    s_add_u32 s34, s31, 4743168
    buffer_load_dwordx4 v3, s[44:47], s34 offen lds
    ds_read_b64_tr_b16 v[36:37], v6 offset:40960
    ds_read_b64_tr_b16 v[38:39], v6 offset:41472
    ds_read_b64_tr_b16 v[48:49], v7 offset:57344
    ds_read_b64_tr_b16 v[50:51], v7 offset:57856
    s_waitcnt lgkmcnt(8)
    v_mfma_f32_32x32x16_bf16 v[16:31], v[40:43], v[52:55], v[16:31]
    s_add_u32 m0, s33, 55296
    s_add_u32 s34, s31, 4767744
    buffer_load_dwordx4 v3, s[44:47], s34 offen lds
    s_add_u32 m0, s33, 56320
    s_add_u32 s34, s31, 4792320
    buffer_load_dwordx4 v3, s[44:47], s34 offen lds
    ds_read_b64_tr_b16 v[40:41], v6 offset:43008
    ds_read_b64_tr_b16 v[42:43], v6 offset:43520
    ds_read_b64_tr_b16 v[52:53], v7 offset:59392
    ds_read_b64_tr_b16 v[54:55], v7 offset:59904
    s_waitcnt lgkmcnt(8)
    v_mfma_f32_32x32x16_bf16 v[16:31], v[32:35], v[44:47], v[16:31]
    s_add_u32 m0, s33, 69632
    s_add_u32 s34, s32, 1966080
    buffer_load_dwordx4 v4, s[40:43], s34 offen lds
    s_add_u32 m0, s33, 70656
    s_add_u32 s34, s32, 1976320
    buffer_load_dwordx4 v4, s[40:43], s34 offen lds
    ds_read_b64_tr_b16 v[32:33], v6 offset:45056
    ds_read_b64_tr_b16 v[34:35], v6 offset:45568
    ds_read_b64_tr_b16 v[44:45], v7 offset:61440
    ds_read_b64_tr_b16 v[46:47], v7 offset:61952
    s_waitcnt lgkmcnt(8)
    v_mfma_f32_32x32x16_bf16 v[16:31], v[36:39], v[48:51], v[16:31]
    s_add_u32 m0, s33, 71680
    s_add_u32 s34, s32, 1986560
    buffer_load_dwordx4 v4, s[40:43], s34 offen lds
    s_add_u32 m0, s33, 72704
    s_add_u32 s34, s32, 1996800
    buffer_load_dwordx4 v4, s[40:43], s34 offen lds
    ds_read_b64_tr_b16 v[36:37], v6 offset:47104
    ds_read_b64_tr_b16 v[38:39], v6 offset:47616
    ds_read_b64_tr_b16 v[48:49], v7 offset:63488
    ds_read_b64_tr_b16 v[50:51], v7 offset:64000
    s_waitcnt lgkmcnt(8)
    v_mfma_f32_32x32x16_bf16 v[16:31], v[40:43], v[52:55], v[16:31]
    s_waitcnt lgkmcnt(4)
    v_mfma_f32_32x32x16_bf16 v[16:31], v[32:35], v[44:47], v[16:31]
    s_waitcnt lgkmcnt(0)
    v_mfma_f32_32x32x16_bf16 v[16:31], v[36:39], v[48:51], v[16:31]
    s_waitcnt vmcnt(12)
    s_barrier
    ds_read_b64_tr_b16 v[32:33], v12 offset:0
    ds_read_b64_tr_b16 v[34:35], v12 offset:512
    ds_read_b64_tr_b16 v[44:45], v13 offset:16384
    ds_read_b64_tr_b16 v[46:47], v13 offset:16896
    ds_read_b64_tr_b16 v[36:37], v12 offset:2048
    ds_read_b64_tr_b16 v[38:39], v12 offset:2560
    ds_read_b64_tr_b16 v[48:49], v13 offset:18432
    ds_read_b64_tr_b16 v[50:51], v13 offset:18944
    s_add_u32 m0, s58, 13312
    s_add_u32 s34, s58, 53248
    buffer_load_dwordx4 v8, s[8:11], s34 offen lds
    s_add_u32 m0, s57, 18432
    s_add_u32 s34, s59, 3328
    buffer_load_dwordx4 v5, s[16:19], s34 offen lds
    ds_read_b64_tr_b16 v[40:41], v12 offset:4096
    ds_read_b64_tr_b16 v[42:43], v12 offset:4608
    ds_read_b64_tr_b16 v[52:53], v13 offset:20480
    ds_read_b64_tr_b16 v[54:55], v13 offset:20992
    s_waitcnt lgkmcnt(8)
    v_mfma_f32_32x32x16_bf16 v[16:31], v[32:35], v[44:47], v[16:31]
    s_add_u32 m0, s57, 19456
    s_add_u32 s34, s59, 3360
    buffer_load_dwordx4 v5, s[16:19], s34 offen lds
    s_mov_b32 m0, 17408
    s_mov_b32 s34, 13312
    s_mov_b64 exec, s[62:63]
    buffer_load_dwordx4 v9, s[12:15], s34 offen lds
    s_mov_b64 exec, -1
    ds_read_b64_tr_b16 v[32:33], v12 offset:6144
    ds_read_b64_tr_b16 v[34:35], v12 offset:6656
    ds_read_b64_tr_b16 v[44:45], v13 offset:22528
    ds_read_b64_tr_b16 v[46:47], v13 offset:23040
    s_waitcnt lgkmcnt(8)
    v_mfma_f32_32x32x16_bf16 v[16:31], v[36:39], v[48:51], v[16:31]
    s_add_u32 m0, s33, 86016
    s_add_u32 s34, s31, 5111808
    buffer_load_dwordx4 v3, s[44:47], s34 offen lds
    s_add_u32 m0, s33, 87040
    s_add_u32 s34, s31, 5136384
    buffer_load_dwordx4 v3, s[44:47], s34 offen lds
    ds_read_b64_tr_b16 v[36:37], v12 offset:8192
    ds_read_b64_tr_b16 v[38:39], v12 offset:8704
    ds_read_b64_tr_b16 v[48:49], v13 offset:24576
    ds_read_b64_tr_b16 v[50:51], v13 offset:25088
    s_waitcnt lgkmcnt(8)
    v_mfma_f32_32x32x16_bf16 v[16:31], v[40:43], v[52:55], v[16:31]
    s_add_u32 m0, s33, 88064
    s_add_u32 s34, s31, 5160960
    buffer_load_dwordx4 v3, s[44:47], s34 offen lds
    s_add_u32 m0, s33, 89088
    s_add_u32 s34, s31, 5185536
    buffer_load_dwordx4 v3, s[44:47], s34 offen lds
    ds_read_b64_tr_b16 v[40:41], v12 offset:10240
    ds_read_b64_tr_b16 v[42:43], v12 offset:10752
    ds_read_b64_tr_b16 v[52:53], v13 offset:26624
    ds_read_b64_tr_b16 v[54:55], v13 offset:27136
    s_waitcnt lgkmcnt(8)
    v_mfma_f32_32x32x16_bf16 v[16:31], v[32:35], v[44:47], v[16:31]
    s_add_u32 m0, s33, 102400
    s_add_u32 s34, s32, 2129920
    buffer_load_dwordx4 v4, s[40:43], s34 offen lds
    s_add_u32 m0, s33, 103424
    s_add_u32 s34, s32, 2140160
    buffer_load_dwordx4 v4, s[40:43], s34 offen lds
    ds_read_b64_tr_b16 v[32:33], v12 offset:12288
    ds_read_b64_tr_b16 v[34:35], v12 offset:12800
    ds_read_b64_tr_b16 v[44:45], v13 offset:28672
    ds_read_b64_tr_b16 v[46:47], v13 offset:29184
    s_waitcnt lgkmcnt(8)
    v_mfma_f32_32x32x16_bf16 v[16:31], v[36:39], v[48:51], v[16:31]
    s_add_u32 m0, s33, 104448
    s_add_u32 s34, s32, 2150400
    buffer_load_dwordx4 v4, s[40:43], s34 offen lds
    s_add_u32 m0, s33, 105472
    s_add_u32 s34, s32, 2160640
    buffer_load_dwordx4 v4, s[40:43], s34 offen lds
    ds_read_b64_tr_b16 v[36:37], v12 offset:14336
    ds_read_b64_tr_b16 v[38:39], v12 offset:14848
    ds_read_b64_tr_b16 v[48:49], v13 offset:30720
    ds_read_b64_tr_b16 v[50:51], v13 offset:31232
    s_waitcnt lgkmcnt(8)
    v_mfma_f32_32x32x16_bf16 v[16:31], v[40:43], v[52:55], v[16:31]
    s_waitcnt lgkmcnt(4)
    v_mfma_f32_32x32x16_bf16 v[16:31], v[32:35], v[44:47], v[16:31]
    s_waitcnt lgkmcnt(0)
    v_mfma_f32_32x32x16_bf16 v[16:31], v[36:39], v[48:51], v[16:31]
    s_waitcnt vmcnt(12)
    s_barrier
    ds_read_b64_tr_b16 v[32:33], v6 offset:0
    ds_read_b64_tr_b16 v[34:35], v6 offset:512
    ds_read_b64_tr_b16 v[44:45], v7 offset:16384
    ds_read_b64_tr_b16 v[46:47], v7 offset:16896
    ds_read_b64_tr_b16 v[36:37], v6 offset:2048
    ds_read_b64_tr_b16 v[38:39], v6 offset:2560
    ds_read_b64_tr_b16 v[48:49], v7 offset:18432
    ds_read_b64_tr_b16 v[50:51], v7 offset:18944
    s_add_u32 m0, s58, 26624
    s_add_u32 s34, s58, 57344
    buffer_load_dwordx4 v8, s[8:11], s34 offen lds
    s_add_u32 m0, s57, 31744
    s_add_u32 s34, s59, 3584
    buffer_load_dwordx4 v5, s[16:19], s34 offen lds
    ds_read_b64_tr_b16 v[40:41], v6 offset:4096
    ds_read_b64_tr_b16 v[42:43], v6 offset:4608
    ds_read_b64_tr_b16 v[52:53], v7 offset:20480
    ds_read_b64_tr_b16 v[54:55], v7 offset:20992
    s_waitcnt lgkmcnt(8)
    v_mfma_f32_32x32x16_bf16 v[16:31], v[32:35], v[44:47], v[16:31]
    s_add_u32 m0, s57, 32768
    s_add_u32 s34, s59, 3616
    buffer_load_dwordx4 v5, s[16:19], s34 offen lds
    s_mov_b32 m0, 30720
    s_mov_b32 s34, 14336
    s_mov_b64 exec, s[62:63]
    buffer_load_dwordx4 v9, s[12:15], s34 offen lds
    s_mov_b64 exec, -1
    ds_read_b64_tr_b16 v[32:33], v6 offset:6144
    ds_read_b64_tr_b16 v[34:35], v6 offset:6656
    ds_read_b64_tr_b16 v[44:45], v7 offset:22528
    ds_read_b64_tr_b16 v[46:47], v7 offset:23040
    s_waitcnt lgkmcnt(8)
    v_mfma_f32_32x32x16_bf16 v[16:31], v[36:39], v[48:51], v[16:31]
    s_add_u32 m0, s33, 118784
    s_add_u32 s34, s31, 5505024
    buffer_load_dwordx4 v3, s[44:47], s34 offen lds
    s_add_u32 m0, s33, 119808
    s_add_u32 s34, s31, 5529600
    buffer_load_dwordx4 v3, s[44:47], s34 offen lds
    ds_read_b64_tr_b16 v[36:37], v6 offset:8192
    ds_read_b64_tr_b16 v[38:39], v6 offset:8704
    ds_read_b64_tr_b16 v[48:49], v7 offset:24576
    ds_read_b64_tr_b16 v[50:51], v7 offset:25088
    s_waitcnt lgkmcnt(8)
    v_mfma_f32_32x32x16_bf16 v[16:31], v[40:43], v[52:55], v[16:31]
    s_add_u32 m0, s33, 120832
    s_add_u32 s34, s31, 5554176
    buffer_load_dwordx4 v3, s[44:47], s34 offen lds
    s_add_u32 m0, s33, 121856
    s_add_u32 s34, s31, 5578752
    buffer_load_dwordx4 v3, s[44:47], s34 offen lds
    ds_read_b64_tr_b16 v[40:41], v6 offset:10240
    ds_read_b64_tr_b16 v[42:43], v6 offset:10752
    ds_read_b64_tr_b16 v[52:53], v7 offset:26624
    ds_read_b64_tr_b16 v[54:55], v7 offset:27136
    s_waitcnt lgkmcnt(8)
    v_mfma_f32_32x32x16_bf16 v[16:31], v[32:35], v[44:47], v[16:31]
    s_add_u32 m0, s33, 135168
    s_add_u32 s34, s32, 2293760
    buffer_load_dwordx4 v4, s[40:43], s34 offen lds
    s_add_u32 m0, s33, 136192
    s_add_u32 s34, s32, 2304000
    buffer_load_dwordx4 v4, s[40:43], s34 offen lds
    ds_read_b64_tr_b16 v[32:33], v6 offset:12288
    ds_read_b64_tr_b16 v[34:35], v6 offset:12800
    ds_read_b64_tr_b16 v[44:45], v7 offset:28672
    ds_read_b64_tr_b16 v[46:47], v7 offset:29184
    s_waitcnt lgkmcnt(8)
    v_mfma_f32_32x32x16_bf16 v[16:31], v[36:39], v[48:51], v[16:31]
    s_add_u32 m0, s33, 137216
    s_add_u32 s34, s32, 2314240
    buffer_load_dwordx4 v4, s[40:43], s34 offen lds
    s_add_u32 m0, s33, 138240
    s_add_u32 s34, s32, 2324480
    buffer_load_dwordx4 v4, s[40:43], s34 offen lds
    ds_read_b64_tr_b16 v[36:37], v6 offset:14336
    ds_read_b64_tr_b16 v[38:39], v6 offset:14848
    ds_read_b64_tr_b16 v[48:49], v7 offset:30720
    ds_read_b64_tr_b16 v[50:51], v7 offset:31232
    s_waitcnt lgkmcnt(8)
    v_mfma_f32_32x32x16_bf16 v[16:31], v[40:43], v[52:55], v[16:31]
    s_waitcnt lgkmcnt(4)
    v_mfma_f32_32x32x16_bf16 v[16:31], v[32:35], v[44:47], v[16:31]
    s_waitcnt lgkmcnt(0)
    v_mfma_f32_32x32x16_bf16 v[16:31], v[36:39], v[48:51], v[16:31]
    s_waitcnt vmcnt(12)
    s_barrier
    ds_read_b64_tr_b16 v[32:33], v6 offset:32768
    ds_read_b64_tr_b16 v[34:35], v6 offset:33280
    ds_read_b64_tr_b16 v[44:45], v7 offset:49152
    ds_read_b64_tr_b16 v[46:47], v7 offset:49664
    ds_read_b64_tr_b16 v[36:37], v6 offset:34816
    ds_read_b64_tr_b16 v[38:39], v6 offset:35328
    ds_read_b64_tr_b16 v[48:49], v7 offset:51200
    ds_read_b64_tr_b16 v[50:51], v7 offset:51712
    s_add_u32 m0, s58, 39936
    s_add_u32 s34, s58, 61440
    buffer_load_dwordx4 v8, s[8:11], s34 offen lds
    s_add_u32 m0, s57, 45056
    s_add_u32 s34, s59, 3840
    buffer_load_dwordx4 v5, s[16:19], s34 offen lds
    ds_read_b64_tr_b16 v[40:41], v6 offset:36864
    ds_read_b64_tr_b16 v[42:43], v6 offset:37376
    ds_read_b64_tr_b16 v[52:53], v7 offset:53248
    ds_read_b64_tr_b16 v[54:55], v7 offset:53760
    s_waitcnt lgkmcnt(8)
    v_mfma_f32_32x32x16_bf16 v[16:31], v[32:35], v[44:47], v[16:31]
    s_add_u32 m0, s57, 46080
    s_add_u32 s34, s59, 3872
    buffer_load_dwordx4 v5, s[16:19], s34 offen lds
    s_mov_b32 m0, 44032
    s_mov_b32 s34, 15360
    s_mov_b64 exec, s[62:63]
    buffer_load_dwordx4 v9, s[12:15], s34 offen lds
    s_mov_b64 exec, -1
    ds_read_b64_tr_b16 v[32:33], v6 offset:38912
    ds_read_b64_tr_b16 v[34:35], v6 offset:39424
    ds_read_b64_tr_b16 v[44:45], v7 offset:55296
    ds_read_b64_tr_b16 v[46:47], v7 offset:55808
    s_waitcnt lgkmcnt(8)
    v_mfma_f32_32x32x16_bf16 v[16:31], v[36:39], v[48:51], v[16:31]
    s_add_u32 m0, s33, 53248
    s_add_u32 s34, s31, 5898240
    buffer_load_dwordx4 v3, s[44:47], s34 offen lds
    s_add_u32 m0, s33, 54272
    s_add_u32 s34, s31, 5922816
    buffer_load_dwordx4 v3, s[44:47], s34 offen lds
    ds_read_b64_tr_b16 v[36:37], v6 offset:40960
    ds_read_b64_tr_b16 v[38:39], v6 offset:41472
    ds_read_b64_tr_b16 v[48:49], v7 offset:57344
    ds_read_b64_tr_b16 v[50:51], v7 offset:57856
    s_waitcnt lgkmcnt(8)
    v_mfma_f32_32x32x16_bf16 v[16:31], v[40:43], v[52:55], v[16:31]
    s_add_u32 m0, s33, 55296
    s_add_u32 s34, s31, 5947392
    buffer_load_dwordx4 v3, s[44:47], s34 offen lds
    s_add_u32 m0, s33, 56320
    s_add_u32 s34, s31, 5971968
    buffer_load_dwordx4 v3, s[44:47], s34 offen lds
    ds_read_b64_tr_b16 v[40:41], v6 offset:43008
    ds_read_b64_tr_b16 v[42:43], v6 offset:43520
    ds_read_b64_tr_b16 v[52:53], v7 offset:59392
    ds_read_b64_tr_b16 v[54:55], v7 offset:59904
    s_waitcnt lgkmcnt(8)
    v_mfma_f32_32x32x16_bf16 v[16:31], v[32:35], v[44:47], v[16:31]
    s_add_u32 m0, s33, 69632
    s_add_u32 s34, s32, 2457600
    buffer_load_dwordx4 v4, s[40:43], s34 offen lds
    s_add_u32 m0, s33, 70656
    s_add_u32 s34, s32, 2467840
    buffer_load_dwordx4 v4, s[40:43], s34 offen lds
    ds_read_b64_tr_b16 v[32:33], v6 offset:45056
    ds_read_b64_tr_b16 v[34:35], v6 offset:45568
    ds_read_b64_tr_b16 v[44:45], v7 offset:61440
    ds_read_b64_tr_b16 v[46:47], v7 offset:61952
    s_waitcnt lgkmcnt(8)
    v_mfma_f32_32x32x16_bf16 v[16:31], v[36:39], v[48:51], v[16:31]
    s_add_u32 m0, s33, 71680
    s_add_u32 s34, s32, 2478080
    buffer_load_dwordx4 v4, s[40:43], s34 offen lds
    s_add_u32 m0, s33, 72704
    s_add_u32 s34, s32, 2488320
    buffer_load_dwordx4 v4, s[40:43], s34 offen lds
    ds_read_b64_tr_b16 v[36:37], v6 offset:47104
    ds_read_b64_tr_b16 v[38:39], v6 offset:47616
    ds_read_b64_tr_b16 v[48:49], v7 offset:63488
    ds_read_b64_tr_b16 v[50:51], v7 offset:64000
    s_waitcnt lgkmcnt(8)
    v_mfma_f32_32x32x16_bf16 v[16:31], v[40:43], v[52:55], v[16:31]
    s_waitcnt lgkmcnt(4)
    v_mfma_f32_32x32x16_bf16 v[16:31], v[32:35], v[44:47], v[16:31]
    s_waitcnt lgkmcnt(0)
    v_mfma_f32_32x32x16_bf16 v[16:31], v[36:39], v[48:51], v[16:31]
    s_waitcnt vmcnt(12)
    s_barrier
    ds_read_b64_tr_b16 v[32:33], v12 offset:0
    ds_read_b64_tr_b16 v[34:35], v12 offset:512
    ds_read_b64_tr_b16 v[44:45], v13 offset:16384
    ds_read_b64_tr_b16 v[46:47], v13 offset:16896
    ds_read_b64_tr_b16 v[36:37], v12 offset:2048
    ds_read_b64_tr_b16 v[38:39], v12 offset:2560
    ds_read_b64_tr_b16 v[48:49], v13 offset:18432
    ds_read_b64_tr_b16 v[50:51], v13 offset:18944
    ds_read_b64_tr_b16 v[40:41], v12 offset:4096
    ds_read_b64_tr_b16 v[42:43], v12 offset:4608
    ds_read_b64_tr_b16 v[52:53], v13 offset:20480
    ds_read_b64_tr_b16 v[54:55], v13 offset:20992
    s_waitcnt lgkmcnt(8)
    v_mfma_f32_32x32x16_bf16 v[16:31], v[32:35], v[44:47], v[16:31]
    ds_read_b64_tr_b16 v[32:33], v12 offset:6144
    ds_read_b64_tr_b16 v[34:35], v12 offset:6656
    ds_read_b64_tr_b16 v[44:45], v13 offset:22528
    ds_read_b64_tr_b16 v[46:47], v13 offset:23040
    s_waitcnt lgkmcnt(8)
    v_mfma_f32_32x32x16_bf16 v[16:31], v[36:39], v[48:51], v[16:31]
    ds_read_b64_tr_b16 v[36:37], v12 offset:8192
    ds_read_b64_tr_b16 v[38:39], v12 offset:8704
    ds_read_b64_tr_b16 v[48:49], v13 offset:24576
    ds_read_b64_tr_b16 v[50:51], v13 offset:25088
    s_waitcnt lgkmcnt(8)
    v_mfma_f32_32x32x16_bf16 v[16:31], v[40:43], v[52:55], v[16:31]
    ds_read_b64_tr_b16 v[40:41], v12 offset:10240
    ds_read_b64_tr_b16 v[42:43], v12 offset:10752
    ds_read_b64_tr_b16 v[52:53], v13 offset:26624
    ds_read_b64_tr_b16 v[54:55], v13 offset:27136
    s_waitcnt lgkmcnt(8)
    v_mfma_f32_32x32x16_bf16 v[16:31], v[32:35], v[44:47], v[16:31]
    ds_read_b64_tr_b16 v[32:33], v12 offset:12288
    ds_read_b64_tr_b16 v[34:35], v12 offset:12800
    ds_read_b64_tr_b16 v[44:45], v13 offset:28672
    ds_read_b64_tr_b16 v[46:47], v13 offset:29184
    s_waitcnt lgkmcnt(8)
    v_mfma_f32_32x32x16_bf16 v[16:31], v[36:39], v[48:51], v[16:31]
    ds_read_b64_tr_b16 v[36:37], v12 offset:14336
    ds_read_b64_tr_b16 v[38:39], v12 offset:14848
    ds_read_b64_tr_b16 v[48:49], v13 offset:30720
    ds_read_b64_tr_b16 v[50:51], v13 offset:31232
    s_waitcnt lgkmcnt(8)
    v_mfma_f32_32x32x16_bf16 v[16:31], v[40:43], v[52:55], v[16:31]
    s_waitcnt lgkmcnt(4)
    v_mfma_f32_32x32x16_bf16 v[16:31], v[32:35], v[44:47], v[16:31]
    s_waitcnt lgkmcnt(0)
    v_mfma_f32_32x32x16_bf16 v[16:31], v[36:39], v[48:51], v[16:31]
    s_waitcnt vmcnt(0)
    s_barrier
    ds_read_b64_tr_b16 v[32:33], v6 offset:0
    ds_read_b64_tr_b16 v[34:35], v6 offset:512
    ds_read_b64_tr_b16 v[44:45], v7 offset:16384
    ds_read_b64_tr_b16 v[46:47], v7 offset:16896
    ds_read_b64_tr_b16 v[36:37], v6 offset:2048
    ds_read_b64_tr_b16 v[38:39], v6 offset:2560
    ds_read_b64_tr_b16 v[48:49], v7 offset:18432
    ds_read_b64_tr_b16 v[50:51], v7 offset:18944
    ds_read_b64_tr_b16 v[40:41], v6 offset:4096
    ds_read_b64_tr_b16 v[42:43], v6 offset:4608
    ds_read_b64_tr_b16 v[52:53], v7 offset:20480
    ds_read_b64_tr_b16 v[54:55], v7 offset:20992
    s_waitcnt lgkmcnt(8)
    v_mfma_f32_32x32x16_bf16 v[16:31], v[32:35], v[44:47], v[16:31]
    ds_read_b64_tr_b16 v[32:33], v6 offset:6144
    ds_read_b64_tr_b16 v[34:35], v6 offset:6656
    ds_read_b64_tr_b16 v[44:45], v7 offset:22528
    ds_read_b64_tr_b16 v[46:47], v7 offset:23040
    s_waitcnt lgkmcnt(8)
    v_mfma_f32_32x32x16_bf16 v[16:31], v[36:39], v[48:51], v[16:31]
    ds_read_b64_tr_b16 v[36:37], v6 offset:8192
    ds_read_b64_tr_b16 v[38:39], v6 offset:8704
    ds_read_b64_tr_b16 v[48:49], v7 offset:24576
    ds_read_b64_tr_b16 v[50:51], v7 offset:25088
    s_waitcnt lgkmcnt(8)
    v_mfma_f32_32x32x16_bf16 v[16:31], v[40:43], v[52:55], v[16:31]
    ds_read_b64_tr_b16 v[40:41], v6 offset:10240
    ds_read_b64_tr_b16 v[42:43], v6 offset:10752
    ds_read_b64_tr_b16 v[52:53], v7 offset:26624
    ds_read_b64_tr_b16 v[54:55], v7 offset:27136
    s_waitcnt lgkmcnt(8)
    v_mfma_f32_32x32x16_bf16 v[16:31], v[32:35], v[44:47], v[16:31]
    ds_read_b64_tr_b16 v[32:33], v6 offset:12288
    ds_read_b64_tr_b16 v[34:35], v6 offset:12800
    ds_read_b64_tr_b16 v[44:45], v7 offset:28672
    ds_read_b64_tr_b16 v[46:47], v7 offset:29184
    s_waitcnt lgkmcnt(8)
    v_mfma_f32_32x32x16_bf16 v[16:31], v[36:39], v[48:51], v[16:31]
    ds_read_b64_tr_b16 v[36:37], v6 offset:14336
    ds_read_b64_tr_b16 v[38:39], v6 offset:14848
    ds_read_b64_tr_b16 v[48:49], v7 offset:30720
    ds_read_b64_tr_b16 v[50:51], v7 offset:31232
    s_waitcnt lgkmcnt(8)
    v_mfma_f32_32x32x16_bf16 v[16:31], v[40:43], v[52:55], v[16:31]
    s_waitcnt lgkmcnt(4)
    v_mfma_f32_32x32x16_bf16 v[16:31], v[32:35], v[44:47], v[16:31]
    s_waitcnt lgkmcnt(0)
    v_mfma_f32_32x32x16_bf16 v[16:31], v[36:39], v[48:51], v[16:31]
    v_and_b32 v10, 31, v2
    s_lshl_b32 s34, s22, 6
    s_lshl_b32 s39, s36, 5
    s_add_u32 s34, s34, s39
    v_add_u32 v10, s34, v10
    v_mul_lo_u32 v10, v10, s24
    v_lshrrev_b32 v11, 5, v2
    v_lshlrev_b32 v11, 3, v11
    s_lshl_b32 s34, s23, 7
    s_lshl_b32 s39, s35, 6
    s_add_u32 s34, s34, s39
    v_add_u32 v11, s34, v11
    v_add_u32 v10, v10, v11
    buffer_load_dwordx2 v[56:57], v11, s[48:51], 0 offen offset:0
    buffer_load_dwordx2 v[58:59], v11, s[48:51], 0 offen offset:16
    buffer_load_dwordx2 v[60:61], v11, s[48:51], 0 offen offset:32
    buffer_load_dwordx2 v[62:63], v11, s[48:51], 0 offen offset:48
    s_mov_b32 s34, 0x3d372713
    s_mov_b32 s39, 0xc0135761
    s_waitcnt vmcnt(0)
    s_nop 7
    v_cvt_pk_bf16_f32 v64, v16, v17
    v_lshlrev_b32 v65, 16, v64
    v_and_b32 v64, 0xffff0000, v64
    v_lshlrev_b32 v66, 16, v56
    v_and_b32 v67, 0xffff0000, v56
    v_add_f32 v65, v65, v66
    v_add_f32 v64, v64, v67
    v_cvt_pk_bf16_f32 v64, v65, v64
    v_lshlrev_b32 v65, 16, v64
    v_and_b32 v64, 0xffff0000, v64
    v_mul_f32 v66, v65, v65
    v_mul_f32 v67, v64, v64
    v_fma_f32 v66, v66, s34, 1.0
    v_fma_f32 v67, v67, s34, 1.0
    v_mul_f32 v66, v66, v65
    v_mul_f32 v67, v67, v64
    v_mul_f32 v66, s39, v66
    v_mul_f32 v67, s39, v67
    v_exp_f32 v66, v66
    v_exp_f32 v67, v67
    s_nop 0
    v_add_f32 v66, 1.0, v66
    v_add_f32 v67, 1.0, v67
    v_rcp_f32 v66, v66
    v_rcp_f32 v67, v67
    s_nop 0
    v_mul_f32 v66, v66, v65
    v_mul_f32 v67, v67, v64
    v_cvt_pk_bf16_f32 v68, v66, v67
    v_cvt_pk_bf16_f32 v64, v18, v19
    v_lshlrev_b32 v65, 16, v64
    v_and_b32 v64, 0xffff0000, v64
    v_lshlrev_b32 v66, 16, v57
    v_and_b32 v67, 0xffff0000, v57
    v_add_f32 v65, v65, v66
    v_add_f32 v64, v64, v67
    v_cvt_pk_bf16_f32 v64, v65, v64
    v_lshlrev_b32 v65, 16, v64
    v_and_b32 v64, 0xffff0000, v64
    v_mul_f32 v66, v65, v65
    v_mul_f32 v67, v64, v64
    v_fma_f32 v66, v66, s34, 1.0
    v_fma_f32 v67, v67, s34, 1.0
    v_mul_f32 v66, v66, v65
    v_mul_f32 v67, v67, v64
    v_mul_f32 v66, s39, v66
    v_mul_f32 v67, s39, v67
    v_exp_f32 v66, v66
    v_exp_f32 v67, v67
    s_nop 0
    v_add_f32 v66, 1.0, v66
    v_add_f32 v67, 1.0, v67
    v_rcp_f32 v66, v66
    v_rcp_f32 v67, v67
    s_nop 0
    v_mul_f32 v66, v66, v65
    v_mul_f32 v67, v67, v64
    v_cvt_pk_bf16_f32 v69, v66, v67
    v_cvt_pk_bf16_f32 v64, v20, v21
    v_lshlrev_b32 v65, 16, v64
    v_and_b32 v64, 0xffff0000, v64
    v_lshlrev_b32 v66, 16, v58
    v_and_b32 v67, 0xffff0000, v58
    v_add_f32 v65, v65, v66
    v_add_f32 v64, v64, v67
    v_cvt_pk_bf16_f32 v64, v65, v64
    v_lshlrev_b32 v65, 16, v64
    v_and_b32 v64, 0xffff0000, v64
    v_mul_f32 v66, v65, v65
    v_mul_f32 v67, v64, v64
    v_fma_f32 v66, v66, s34, 1.0
    v_fma_f32 v67, v67, s34, 1.0
    v_mul_f32 v66, v66, v65
    v_mul_f32 v67, v67, v64
    v_mul_f32 v66, s39, v66
    v_mul_f32 v67, s39, v67
    v_exp_f32 v66, v66
    v_exp_f32 v67, v67
    s_nop 0
    v_add_f32 v66, 1.0, v66
    v_add_f32 v67, 1.0, v67
    v_rcp_f32 v66, v66
    v_rcp_f32 v67, v67
    s_nop 0
    v_mul_f32 v66, v66, v65
    v_mul_f32 v67, v67, v64
    v_cvt_pk_bf16_f32 v70, v66, v67
    v_cvt_pk_bf16_f32 v64, v22, v23
    v_lshlrev_b32 v65, 16, v64
    v_and_b32 v64, 0xffff0000, v64
    v_lshlrev_b32 v66, 16, v59
    v_and_b32 v67, 0xffff0000, v59
    v_add_f32 v65, v65, v66
    v_add_f32 v64, v64, v67
    v_cvt_pk_bf16_f32 v64, v65, v64
    v_lshlrev_b32 v65, 16, v64
    v_and_b32 v64, 0xffff0000, v64
    v_mul_f32 v66, v65, v65
    v_mul_f32 v67, v64, v64
    v_fma_f32 v66, v66, s34, 1.0
    v_fma_f32 v67, v67, s34, 1.0
    v_mul_f32 v66, v66, v65
    v_mul_f32 v67, v67, v64
    v_mul_f32 v66, s39, v66
    v_mul_f32 v67, s39, v67
    v_exp_f32 v66, v66
    v_exp_f32 v67, v67
    s_nop 0
    v_add_f32 v66, 1.0, v66
    v_add_f32 v67, 1.0, v67
    v_rcp_f32 v66, v66
    v_rcp_f32 v67, v67
    s_nop 0
    v_mul_f32 v66, v66, v65
    v_mul_f32 v67, v67, v64
    v_cvt_pk_bf16_f32 v71, v66, v67
    v_cvt_pk_bf16_f32 v64, v24, v25
    v_lshlrev_b32 v65, 16, v64
    v_and_b32 v64, 0xffff0000, v64
    v_lshlrev_b32 v66, 16, v60
    v_and_b32 v67, 0xffff0000, v60
    v_add_f32 v65, v65, v66
    v_add_f32 v64, v64, v67
    v_cvt_pk_bf16_f32 v64, v65, v64
    v_lshlrev_b32 v65, 16, v64
    v_and_b32 v64, 0xffff0000, v64
    v_mul_f32 v66, v65, v65
    v_mul_f32 v67, v64, v64
    v_fma_f32 v66, v66, s34, 1.0
    v_fma_f32 v67, v67, s34, 1.0
    v_mul_f32 v66, v66, v65
    v_mul_f32 v67, v67, v64
    v_mul_f32 v66, s39, v66
    v_mul_f32 v67, s39, v67
    v_exp_f32 v66, v66
    v_exp_f32 v67, v67
    s_nop 0
    v_add_f32 v66, 1.0, v66
    v_add_f32 v67, 1.0, v67
    v_rcp_f32 v66, v66
    v_rcp_f32 v67, v67
    s_nop 0
    v_mul_f32 v66, v66, v65
    v_mul_f32 v67, v67, v64
    v_cvt_pk_bf16_f32 v72, v66, v67
    v_cvt_pk_bf16_f32 v64, v26, v27
    v_lshlrev_b32 v65, 16, v64
    v_and_b32 v64, 0xffff0000, v64
    v_lshlrev_b32 v66, 16, v61
    v_and_b32 v67, 0xffff0000, v61
    v_add_f32 v65, v65, v66
    v_add_f32 v64, v64, v67
    v_cvt_pk_bf16_f32 v64, v65, v64
    v_lshlrev_b32 v65, 16, v64
    v_and_b32 v64, 0xffff0000, v64
    v_mul_f32 v66, v65, v65
    v_mul_f32 v67, v64, v64
    v_fma_f32 v66, v66, s34, 1.0
    v_fma_f32 v67, v67, s34, 1.0
    v_mul_f32 v66, v66, v65
    v_mul_f32 v67, v67, v64
    v_mul_f32 v66, s39, v66
    v_mul_f32 v67, s39, v67
    v_exp_f32 v66, v66
    v_exp_f32 v67, v67
    s_nop 0
    v_add_f32 v66, 1.0, v66
    v_add_f32 v67, 1.0, v67
    v_rcp_f32 v66, v66
    v_rcp_f32 v67, v67
    s_nop 0
    v_mul_f32 v66, v66, v65
    v_mul_f32 v67, v67, v64
    v_cvt_pk_bf16_f32 v73, v66, v67
    v_cvt_pk_bf16_f32 v64, v28, v29
    v_lshlrev_b32 v65, 16, v64
    v_and_b32 v64, 0xffff0000, v64
    v_lshlrev_b32 v66, 16, v62
    v_and_b32 v67, 0xffff0000, v62
    v_add_f32 v65, v65, v66
    v_add_f32 v64, v64, v67
    v_cvt_pk_bf16_f32 v64, v65, v64
    v_lshlrev_b32 v65, 16, v64
    v_and_b32 v64, 0xffff0000, v64
    v_mul_f32 v66, v65, v65
    v_mul_f32 v67, v64, v64
    v_fma_f32 v66, v66, s34, 1.0
    v_fma_f32 v67, v67, s34, 1.0
    v_mul_f32 v66, v66, v65
    v_mul_f32 v67, v67, v64
    v_mul_f32 v66, s39, v66
    v_mul_f32 v67, s39, v67
    v_exp_f32 v66, v66
    v_exp_f32 v67, v67
    s_nop 0
    v_add_f32 v66, 1.0, v66
    v_add_f32 v67, 1.0, v67
    v_rcp_f32 v66, v66
    v_rcp_f32 v67, v67
    s_nop 0
    v_mul_f32 v66, v66, v65
    v_mul_f32 v67, v67, v64
    v_cvt_pk_bf16_f32 v74, v66, v67
    v_cvt_pk_bf16_f32 v64, v30, v31
    v_lshlrev_b32 v65, 16, v64
    v_and_b32 v64, 0xffff0000, v64
    v_lshlrev_b32 v66, 16, v63
    v_and_b32 v67, 0xffff0000, v63
    v_add_f32 v65, v65, v66
    v_add_f32 v64, v64, v67
    v_cvt_pk_bf16_f32 v64, v65, v64
    v_lshlrev_b32 v65, 16, v64
    v_and_b32 v64, 0xffff0000, v64
    v_mul_f32 v66, v65, v65
    v_mul_f32 v67, v64, v64
    v_fma_f32 v66, v66, s34, 1.0
    v_fma_f32 v67, v67, s34, 1.0
    v_mul_f32 v66, v66, v65
    v_mul_f32 v67, v67, v64
    v_mul_f32 v66, s39, v66
    v_mul_f32 v67, s39, v67
    v_exp_f32 v66, v66
    v_exp_f32 v67, v67
    s_nop 0
    v_add_f32 v66, 1.0, v66
    v_add_f32 v67, 1.0, v67
    v_rcp_f32 v66, v66
    v_rcp_f32 v67, v67
    s_nop 0
    v_mul_f32 v66, v66, v65
    v_mul_f32 v67, v67, v64
    v_cvt_pk_bf16_f32 v75, v66, v67
    buffer_store_dwordx2 v[68:69], v10, s[52:55], 0 offen offset:0
    buffer_store_dwordx2 v[70:71], v10, s[52:55], 0 offen offset:16
    buffer_store_dwordx2 v[72:73], v10, s[52:55], 0 offen offset:32
    buffer_store_dwordx2 v[74:75], v10, s[52:55], 0 offen offset:48
    s_waitcnt vmcnt(0)
    s_barrier
    s_endpgm
K2_KVONLY:
    s_add_u32 m0, s58, 0
    s_add_u32 s34, s58, 0
    buffer_load_dwordx4 v8, s[8:11], s34 offen lds
    s_add_u32 m0, s57, 5120
    s_add_u32 s34, s59, 0
    buffer_load_dwordx4 v5, s[16:19], s34 offen lds
    s_add_u32 m0, s57, 6144
    s_add_u32 s34, s59, 32
    buffer_load_dwordx4 v5, s[16:19], s34 offen lds
    s_mov_b32 m0, 4096
    s_mov_b32 s34, 0
    s_mov_b64 exec, s[62:63]
    buffer_load_dwordx4 v9, s[12:15], s34 offen lds
    s_mov_b64 exec, -1
    s_add_u32 m0, s58, 13312
    s_add_u32 s34, s58, 4096
    buffer_load_dwordx4 v8, s[8:11], s34 offen lds
    s_add_u32 m0, s57, 18432
    s_add_u32 s34, s59, 256
    buffer_load_dwordx4 v5, s[16:19], s34 offen lds
    s_add_u32 m0, s57, 19456
    s_add_u32 s34, s59, 288
    buffer_load_dwordx4 v5, s[16:19], s34 offen lds
    s_mov_b32 m0, 17408
    s_mov_b32 s34, 1024
    s_mov_b64 exec, s[62:63]
    buffer_load_dwordx4 v9, s[12:15], s34 offen lds
    s_mov_b64 exec, -1
    s_add_u32 m0, s58, 26624
    s_add_u32 s34, s58, 8192
    buffer_load_dwordx4 v8, s[8:11], s34 offen lds
    s_add_u32 m0, s57, 31744
    s_add_u32 s34, s59, 512
    buffer_load_dwordx4 v5, s[16:19], s34 offen lds
    s_add_u32 m0, s57, 32768
    s_add_u32 s34, s59, 544
    buffer_load_dwordx4 v5, s[16:19], s34 offen lds
    s_mov_b32 m0, 30720
    s_mov_b32 s34, 2048
    s_mov_b64 exec, s[62:63]
    buffer_load_dwordx4 v9, s[12:15], s34 offen lds
    s_mov_b64 exec, -1
    s_waitcnt vmcnt(4)
    s_barrier
    s_add_u32 m0, s58, 39936
    s_add_u32 s34, s58, 12288
    buffer_load_dwordx4 v8, s[8:11], s34 offen lds
    s_add_u32 m0, s57, 45056
    s_add_u32 s34, s59, 768
    buffer_load_dwordx4 v5, s[16:19], s34 offen lds
    s_add_u32 m0, s57, 46080
    s_add_u32 s34, s59, 800
    buffer_load_dwordx4 v5, s[16:19], s34 offen lds
    s_mov_b32 m0, 44032
    s_mov_b32 s34, 3072
    s_mov_b64 exec, s[62:63]
    buffer_load_dwordx4 v9, s[12:15], s34 offen lds
    s_mov_b64 exec, -1
    s_waitcnt vmcnt(4)
    s_barrier
    s_add_u32 m0, s58, 0
    s_add_u32 s34, s58, 16384
    buffer_load_dwordx4 v8, s[8:11], s34 offen lds
    s_add_u32 m0, s57, 5120
    s_add_u32 s34, s59, 1024
    buffer_load_dwordx4 v5, s[16:19], s34 offen lds
    s_add_u32 m0, s57, 6144
    s_add_u32 s34, s59, 1056
    buffer_load_dwordx4 v5, s[16:19], s34 offen lds
    s_mov_b32 m0, 4096
    s_mov_b32 s34, 4096
    s_mov_b64 exec, s[62:63]
    buffer_load_dwordx4 v9, s[12:15], s34 offen lds
    s_mov_b64 exec, -1
    s_waitcnt vmcnt(4)
    s_barrier
    s_add_u32 m0, s58, 13312
    s_add_u32 s34, s58, 20480
    buffer_load_dwordx4 v8, s[8:11], s34 offen lds
    s_add_u32 m0, s57, 18432
    s_add_u32 s34, s59, 1280
    buffer_load_dwordx4 v5, s[16:19], s34 offen lds
    s_add_u32 m0, s57, 19456
    s_add_u32 s34, s59, 1312
    buffer_load_dwordx4 v5, s[16:19], s34 offen lds
    s_mov_b32 m0, 17408
    s_mov_b32 s34, 5120
    s_mov_b64 exec, s[62:63]
    buffer_load_dwordx4 v9, s[12:15], s34 offen lds
    s_mov_b64 exec, -1
    s_waitcnt vmcnt(4)
    s_barrier
    s_add_u32 m0, s58, 26624
    s_add_u32 s34, s58, 24576
    buffer_load_dwordx4 v8, s[8:11], s34 offen lds
    s_add_u32 m0, s57, 31744
    s_add_u32 s34, s59, 1536
    buffer_load_dwordx4 v5, s[16:19], s34 offen lds
    s_add_u32 m0, s57, 32768
    s_add_u32 s34, s59, 1568
    buffer_load_dwordx4 v5, s[16:19], s34 offen lds
    s_mov_b32 m0, 30720
    s_mov_b32 s34, 6144
    s_mov_b64 exec, s[62:63]
    buffer_load_dwordx4 v9, s[12:15], s34 offen lds
    s_mov_b64 exec, -1
    s_waitcnt vmcnt(4)
    s_barrier
    s_add_u32 m0, s58, 39936
    s_add_u32 s34, s58, 28672
    buffer_load_dwordx4 v8, s[8:11], s34 offen lds
    s_add_u32 m0, s57, 45056
    s_add_u32 s34, s59, 1792
    buffer_load_dwordx4 v5, s[16:19], s34 offen lds
    s_add_u32 m0, s57, 46080
    s_add_u32 s34, s59, 1824
    buffer_load_dwordx4 v5, s[16:19], s34 offen lds
    s_mov_b32 m0, 44032
    s_mov_b32 s34, 7168
    s_mov_b64 exec, s[62:63]
    buffer_load_dwordx4 v9, s[12:15], s34 offen lds
    s_mov_b64 exec, -1
    s_waitcnt vmcnt(4)
    s_barrier
    s_add_u32 m0, s58, 0
    s_add_u32 s34, s58, 32768
    buffer_load_dwordx4 v8, s[8:11], s34 offen lds
    s_add_u32 m0, s57, 5120
    s_add_u32 s34, s59, 2048
    buffer_load_dwordx4 v5, s[16:19], s34 offen lds
    s_add_u32 m0, s57, 6144
    s_add_u32 s34, s59, 2080
    buffer_load_dwordx4 v5, s[16:19], s34 offen lds
    s_mov_b32 m0, 4096
    s_mov_b32 s34, 8192
    s_mov_b64 exec, s[62:63]
    buffer_load_dwordx4 v9, s[12:15], s34 offen lds
    s_mov_b64 exec, -1
    s_waitcnt vmcnt(4)
    s_barrier
    s_mov_b32 s72, s66
    s_and_b32 s73, s67, 0xffff
    s_mov_b32 s74, 6291456
    s_mov_b32 s75, 0x00020000
    s_mov_b32 s76, s68
    s_and_b32 s77, s69, 0xffff
    s_mov_b32 s78, 819200
    s_mov_b32 s79, 0x00020000
    s_lshl_b32 s34, s2, 2
    s_add_u32 s34, s34, s3
    s_mul_i32 s39, s34, 6144
    v_lshlrev_b32 v15, 7, v2
    buffer_load_dword v122, v15, s[72:75], s39 offen
    s_lshl_b32 s39, s34, 13
    buffer_load_dword v121, v15, s[76:79], s39 offen
    s_add_u32 m0, s58, 13312
    s_add_u32 s34, s58, 36864
    buffer_load_dwordx4 v8, s[8:11], s34 offen lds
    s_add_u32 m0, s57, 18432
    s_add_u32 s34, s59, 2304
    buffer_load_dwordx4 v5, s[16:19], s34 offen lds
    s_add_u32 m0, s57, 19456
    s_add_u32 s34, s59, 2336
    buffer_load_dwordx4 v5, s[16:19], s34 offen lds
    s_mov_b32 m0, 17408
    s_mov_b32 s34, 9216
    s_mov_b64 exec, s[62:63]
    buffer_load_dwordx4 v9, s[12:15], s34 offen lds
    s_mov_b64 exec, -1
    s_waitcnt vmcnt(6)
    s_barrier
    s_add_u32 m0, s58, 26624
    s_add_u32 s34, s58, 40960
    buffer_load_dwordx4 v8, s[8:11], s34 offen lds
    s_add_u32 m0, s57, 31744
    s_add_u32 s34, s59, 2560
    buffer_load_dwordx4 v5, s[16:19], s34 offen lds
    s_add_u32 m0, s57, 32768
    s_add_u32 s34, s59, 2592
    buffer_load_dwordx4 v5, s[16:19], s34 offen lds
    s_mov_b32 m0, 30720
    s_mov_b32 s34, 10240
    s_mov_b64 exec, s[62:63]
    buffer_load_dwordx4 v9, s[12:15], s34 offen lds
    s_mov_b64 exec, -1
    s_waitcnt vmcnt(4)
    s_barrier
    s_add_u32 m0, s58, 39936
    s_add_u32 s34, s58, 45056
    buffer_load_dwordx4 v8, s[8:11], s34 offen lds
    s_add_u32 m0, s57, 45056
    s_add_u32 s34, s59, 2816
    buffer_load_dwordx4 v5, s[16:19], s34 offen lds
    s_add_u32 m0, s57, 46080
    s_add_u32 s34, s59, 2848
    buffer_load_dwordx4 v5, s[16:19], s34 offen lds
    s_mov_b32 m0, 44032
    s_mov_b32 s34, 11264
    s_mov_b64 exec, s[62:63]
    buffer_load_dwordx4 v9, s[12:15], s34 offen lds
    s_mov_b64 exec, -1
    s_waitcnt vmcnt(4)
    s_barrier
    s_add_u32 m0, s58, 0
    s_add_u32 s34, s58, 49152
    buffer_load_dwordx4 v8, s[8:11], s34 offen lds
    s_add_u32 m0, s57, 5120
    s_add_u32 s34, s59, 3072
    buffer_load_dwordx4 v5, s[16:19], s34 offen lds
    s_add_u32 m0, s57, 6144
    s_add_u32 s34, s59, 3104
    buffer_load_dwordx4 v5, s[16:19], s34 offen lds
    s_mov_b32 m0, 4096
    s_mov_b32 s34, 12288
    s_mov_b64 exec, s[62:63]
    buffer_load_dwordx4 v9, s[12:15], s34 offen lds
    s_mov_b64 exec, -1
    s_waitcnt vmcnt(4)
    s_barrier
    s_add_u32 m0, s58, 13312
    s_add_u32 s34, s58, 53248
    buffer_load_dwordx4 v8, s[8:11], s34 offen lds
    s_add_u32 m0, s57, 18432
    s_add_u32 s34, s59, 3328
    buffer_load_dwordx4 v5, s[16:19], s34 offen lds
    s_add_u32 m0, s57, 19456
    s_add_u32 s34, s59, 3360
    buffer_load_dwordx4 v5, s[16:19], s34 offen lds
    s_mov_b32 m0, 17408
    s_mov_b32 s34, 13312
    s_mov_b64 exec, s[62:63]
    buffer_load_dwordx4 v9, s[12:15], s34 offen lds
    s_mov_b64 exec, -1
    s_waitcnt vmcnt(4)
    s_barrier
    s_add_u32 m0, s58, 26624
    s_add_u32 s34, s58, 57344
    buffer_load_dwordx4 v8, s[8:11], s34 offen lds
    s_add_u32 m0, s57, 31744
    s_add_u32 s34, s59, 3584
    buffer_load_dwordx4 v5, s[16:19], s34 offen lds
    s_add_u32 m0, s57, 32768
    s_add_u32 s34, s59, 3616
    buffer_load_dwordx4 v5, s[16:19], s34 offen lds
    s_mov_b32 m0, 30720
    s_mov_b32 s34, 14336
    s_mov_b64 exec, s[62:63]
    buffer_load_dwordx4 v9, s[12:15], s34 offen lds
    s_mov_b64 exec, -1
    s_waitcnt vmcnt(4)
    s_barrier
    s_add_u32 m0, s58, 39936
    s_add_u32 s34, s58, 61440
    buffer_load_dwordx4 v8, s[8:11], s34 offen lds
    s_add_u32 m0, s57, 45056
    s_add_u32 s34, s59, 3840
    buffer_load_dwordx4 v5, s[16:19], s34 offen lds
    s_add_u32 m0, s57, 46080
    s_add_u32 s34, s59, 3872
    buffer_load_dwordx4 v5, s[16:19], s34 offen lds
    s_mov_b32 m0, 44032
    s_mov_b32 s34, 15360
    s_mov_b64 exec, s[62:63]
    buffer_load_dwordx4 v9, s[12:15], s34 offen lds
    s_mov_b64 exec, -1
    s_waitcnt vmcnt(4)
    s_barrier
    s_waitcnt vmcnt(0)
    s_barrier
    s_waitcnt vmcnt(0)
    s_barrier
    s_endpgm
K2_END:
    s_endpgm
.globl k3_kernel
.p2align 8
.type k3_kernel,@function
k3_kernel:
    s_cmp_ge_u32 s2, 256
    s_cbranch_scc1 K3_END
    v_lshrrev_b32 v1, 6, v0
    v_and_b32 v2, 63, v0
    s_nop 0
    v_readfirstlane_b32 s3, v1
    s_load_dwordx2 s[20:21], s[0:1], 104
    s_load_dwordx2 s[4:5], s[0:1], 32
    s_load_dwordx2 s[6:7], s[0:1], 64
    s_load_dwordx2 s[22:23], s[0:1], 72
    s_load_dwordx2 s[24:25], s[0:1], 88
    s_waitcnt lgkmcnt(0)
    s_mov_b32 s8, s4
    s_and_b32 s9, s5, 0xffff
    s_mov_b32 s10, 819200
    s_mov_b32 s11, 0x00020000
    s_add_u32 s12, s20, 7397376
    s_addc_u32 s13, s21, 0
    s_and_b32 s13, s13, 0xffff
    s_mov_b32 s14, 2621440
    s_mov_b32 s15, 0x00020000
    s_add_u32 s16, s20, 5431296
    s_addc_u32 s17, s21, 0
    s_and_b32 s17, s17, 0xffff
    s_mov_b32 s18, 1966080
    s_mov_b32 s19, 0x00020000
    s_mov_b32 s40, s6
    s_and_b32 s41, s7, 0xffff
    s_mov_b32 s42, 6291456
    s_mov_b32 s43, 0x00020000
    s_mov_b32 s44, s22
    s_and_b32 s45, s23, 0xffff
    s_mov_b32 s46, 4096
    s_mov_b32 s47, 0x00020000
    s_add_u32 s48, s20, 5423104
    s_addc_u32 s49, s21, 0
    s_and_b32 s49, s49, 0xffff
    s_mov_b32 s50, 8192
    s_mov_b32 s51, 0x00020000
    s_mov_b32 s52, s24
    s_and_b32 s53, s25, 0xffff
    s_mov_b32 s54, 2621440
    s_mov_b32 s55, 0x00020000
    s_and_b32 s60, s2, 7
    s_lshr_b32 s61, s2, 3
    s_lshr_b32 s28, s61, 2
    s_and_b32 s29, s61, 3
    s_and_b32 s34, s60, 3
    s_lshl_b32 s34, s34, 3
    s_add_u32 s28, s28, s34
    s_lshr_b32 s34, s60, 2
    s_lshl_b32 s34, s34, 2
    s_add_u32 s29, s29, s34
    s_mov_b32 s30, 1280
    s_mov_b32 s56, 3072
    s_mov_b32 s57, 4096
    v_and_b32 v4, 15, v2
    v_lshrrev_b32 v5, 4, v2
    s_cmp_ge_u32 s3, 4
    s_cbranch_scc1 K3_LD
    v_lshrrev_b32 v10, 1, v5
    v_lshlrev_b32 v10, 4, v10
    v_and_b32 v11, 1, v5
    v_lshlrev_b32 v11, 2, v11
    v_add_u32 v10, v10, v11
    v_lshrrev_b32 v11, 2, v4
    v_add_u32 v10, v10, v11
    v_mul_u32_u24 v10, 160, v10
    v_and_b32 v11, 3, v4
    v_lshlrev_b32 v11, 3, v11
    v_add_u32 v6, v10, v11
    v_xor_b32 v10, v5, v4
    v_lshlrev_b32 v10, 4, v10
    v_lshlrev_b32 v11, 8, v4
    v_add_u32 v7, v10, v11
    s_lshl_b32 s65, s3, 12
    v_add_u32 v8, s65, v7
    v_and_b32 v10, 3, v4
    v_lshlrev_b32 v10, 3, v10
    s_lshl_b32 s34, s3, 5
    v_add_u32 v10, s34, v10
    v_lshrrev_b32 v11, 3, v4
    v_lshlrev_b32 v11, 6, v11
    v_xor_b32 v10, v10, v11
    v_and_b32 v11, 1, v5
    v_lshlrev_b32 v11, 5, v11
    v_xor_b32 v10, v10, v11
    v_lshlrev_b32 v11, 3, v5
    v_lshrrev_b32 v12, 2, v4
    v_add_u32 v11, v11, v12
    v_lshlrev_b32 v11, 7, v11
    v_add_u32 v9, v10, v11
    s_lshl_b32 s34, s28, 6
    s_lshl_b32 s39, s3, 4
    s_add_u32 s34, s34, s39
    v_add_u32 v10, s34, v4
    v_lshlrev_b32 v11, 2, v10
    v_lshlrev_b32 v12, 1, v10
    buffer_load_dword v80, v11, s[48:51], 0 offen
    buffer_load_ushort v81, v12, s[44:47], 0 offen
    v_mul_lo_u32 v10, v10, s30
    v_lshlrev_b32 v11, 3, v5
    v_add_u32 v10, v10, v11
    s_mul_i32 s34, s29, 160
    v_add_u32 v82, s34, v10
    s_barrier
    v_add_u32 v76, 0, v7
    v_add_u32 v77, 0, v9
    ds_read_b64_tr_b16 v[124:125], v77 offset:20480
    ds_read_b64_tr_b16 v[126:127], v77 offset:20992
    ds_read_b128 v[84:87], v76 offset:0
    ds_read_b128 v[88:91], v76 offset:4096
    ds_read_b128 v[92:95], v76 offset:8192
    ds_read_b128 v[96:99], v76 offset:12288
    ds_read_b128 v[100:103], v76 offset:16384
    ds_read_b64_tr_b16 v[128:129], v77 offset:24576
    ds_read_b64_tr_b16 v[130:131], v77 offset:25088
    v_xor_b32 v15, 64, v76
    ds_read_b128 v[104:107], v15 offset:0
    ds_read_b128 v[108:111], v15 offset:4096
    ds_read_b128 v[112:115], v15 offset:8192
    ds_read_b128 v[116:119], v15 offset:12288
    ds_read_b128 v[120:123], v15 offset:16384
    s_waitcnt lgkmcnt(7)
    v_mfma_f32_16x16x32_bf16 v[36:39], v[84:87], v[124:127], 0
    v_mfma_f32_16x16x32_bf16 v[40:43], v[88:91], v[124:127], 0
    v_mfma_f32_16x16x32_bf16 v[44:47], v[92:95], v[124:127], 0
    v_mfma_f32_16x16x32_bf16 v[48:51], v[96:99], v[124:127], 0
    v_mfma_f32_16x16x32_bf16 v[52:55], v[100:103], v[124:127], 0
    ds_read_b64_tr_b16 v[124:125], v77 offset:28672
    ds_read_b64_tr_b16 v[126:127], v77 offset:29184
    v_xor_b32 v15, 128, v76
    ds_read_b128 v[84:87], v15 offset:0
    ds_read_b128 v[88:91], v15 offset:4096
    ds_read_b128 v[92:95], v15 offset:8192
    ds_read_b128 v[96:99], v15 offset:12288
    ds_read_b128 v[100:103], v15 offset:16384
    s_waitcnt lgkmcnt(7)
    v_mfma_f32_16x16x32_bf16 v[36:39], v[104:107], v[128:131], v[36:39]
    v_mfma_f32_16x16x32_bf16 v[40:43], v[108:111], v[128:131], v[40:43]
    v_mfma_f32_16x16x32_bf16 v[44:47], v[112:115], v[128:131], v[44:47]
    v_mfma_f32_16x16x32_bf16 v[48:51], v[116:119], v[128:131], v[48:51]
    v_mfma_f32_16x16x32_bf16 v[52:55], v[120:123], v[128:131], v[52:55]
    ds_read_b64_tr_b16 v[128:129], v77 offset:32768
    ds_read_b64_tr_b16 v[130:131], v77 offset:33280
    v_xor_b32 v15, 192, v76
    ds_read_b128 v[104:107], v15 offset:0
    ds_read_b128 v[108:111], v15 offset:4096
    ds_read_b128 v[112:115], v15 offset:8192
    ds_read_b128 v[116:119], v15 offset:12288
    ds_read_b128 v[120:123], v15 offset:16384
    s_waitcnt lgkmcnt(7)
    v_mfma_f32_16x16x32_bf16 v[36:39], v[84:87], v[124:127], v[36:39]
    v_mfma_f32_16x16x32_bf16 v[40:43], v[88:91], v[124:127], v[40:43]
    v_mfma_f32_16x16x32_bf16 v[44:47], v[92:95], v[124:127], v[44:47]
    v_mfma_f32_16x16x32_bf16 v[48:51], v[96:99], v[124:127], v[48:51]
    v_mfma_f32_16x16x32_bf16 v[52:55], v[100:103], v[124:127], v[52:55]
    s_waitcnt lgkmcnt(0)
    v_mfma_f32_16x16x32_bf16 v[36:39], v[104:107], v[128:131], v[36:39]
    v_mfma_f32_16x16x32_bf16 v[40:43], v[108:111], v[128:131], v[40:43]
    v_mfma_f32_16x16x32_bf16 v[44:47], v[112:115], v[128:131], v[44:47]
    v_mfma_f32_16x16x32_bf16 v[48:51], v[116:119], v[128:131], v[48:51]
    v_mfma_f32_16x16x32_bf16 v[52:55], v[120:123], v[128:131], v[52:55]
    s_barrier
    v_add_u32 v76, 36864, v7
    v_add_u32 v77, 36864, v9
    ds_read_b64_tr_b16 v[124:125], v77 offset:20480
    ds_read_b64_tr_b16 v[126:127], v77 offset:20992
    ds_read_b128 v[84:87], v76 offset:0
    ds_read_b128 v[88:91], v76 offset:4096
    ds_read_b128 v[92:95], v76 offset:8192
    ds_read_b128 v[96:99], v76 offset:12288
    ds_read_b128 v[100:103], v76 offset:16384
    ds_read_b64_tr_b16 v[128:129], v77 offset:24576
    ds_read_b64_tr_b16 v[130:131], v77 offset:25088
    v_xor_b32 v15, 64, v76
    ds_read_b128 v[104:107], v15 offset:0
    ds_read_b128 v[108:111], v15 offset:4096
    ds_read_b128 v[112:115], v15 offset:8192
    ds_read_b128 v[116:119], v15 offset:12288
    ds_read_b128 v[120:123], v15 offset:16384
    s_waitcnt lgkmcnt(7)
    v_mfma_f32_16x16x32_bf16 v[36:39], v[84:87], v[124:127], v[36:39]
    v_mfma_f32_16x16x32_bf16 v[40:43], v[88:91], v[124:127], v[40:43]
    v_mfma_f32_16x16x32_bf16 v[44:47], v[92:95], v[124:127], v[44:47]
    v_mfma_f32_16x16x32_bf16 v[48:51], v[96:99], v[124:127], v[48:51]
    v_mfma_f32_16x16x32_bf16 v[52:55], v[100:103], v[124:127], v[52:55]
    ds_read_b64_tr_b16 v[124:125], v77 offset:28672
    ds_read_b64_tr_b16 v[126:127], v77 offset:29184
    v_xor_b32 v15, 128, v76
    ds_read_b128 v[84:87], v15 offset:0
    ds_read_b128 v[88:91], v15 offset:4096
    ds_read_b128 v[92:95], v15 offset:8192
    ds_read_b128 v[96:99], v15 offset:12288
    ds_read_b128 v[100:103], v15 offset:16384
    s_waitcnt lgkmcnt(7)
    v_mfma_f32_16x16x32_bf16 v[36:39], v[104:107], v[128:131], v[36:39]
    v_mfma_f32_16x16x32_bf16 v[40:43], v[108:111], v[128:131], v[40:43]
    v_mfma_f32_16x16x32_bf16 v[44:47], v[112:115], v[128:131], v[44:47]
    v_mfma_f32_16x16x32_bf16 v[48:51], v[116:119], v[128:131], v[48:51]
    v_mfma_f32_16x16x32_bf16 v[52:55], v[120:123], v[128:131], v[52:55]
    ds_read_b64_tr_b16 v[128:129], v77 offset:32768
    ds_read_b64_tr_b16 v[130:131], v77 offset:33280
    v_xor_b32 v15, 192, v76
    ds_read_b128 v[104:107], v15 offset:0
    ds_read_b128 v[108:111], v15 offset:4096
    ds_read_b128 v[112:115], v15 offset:8192
    ds_read_b128 v[116:119], v15 offset:12288
    ds_read_b128 v[120:123], v15 offset:16384
    s_waitcnt lgkmcnt(7)
    v_mfma_f32_16x16x32_bf16 v[36:39], v[84:87], v[124:127], v[36:39]
    v_mfma_f32_16x16x32_bf16 v[40:43], v[88:91], v[124:127], v[40:43]
    v_mfma_f32_16x16x32_bf16 v[44:47], v[92:95], v[124:127], v[44:47]
    v_mfma_f32_16x16x32_bf16 v[48:51], v[96:99], v[124:127], v[48:51]
    v_mfma_f32_16x16x32_bf16 v[52:55], v[100:103], v[124:127], v[52:55]
    s_waitcnt lgkmcnt(0)
    v_mfma_f32_16x16x32_bf16 v[36:39], v[104:107], v[128:131], v[36:39]
    v_mfma_f32_16x16x32_bf16 v[40:43], v[108:111], v[128:131], v[40:43]
    v_mfma_f32_16x16x32_bf16 v[44:47], v[112:115], v[128:131], v[44:47]
    v_mfma_f32_16x16x32_bf16 v[48:51], v[116:119], v[128:131], v[48:51]
    v_mfma_f32_16x16x32_bf16 v[52:55], v[120:123], v[128:131], v[52:55]
    s_barrier
    v_add_u32 v76, 73728, v7
    v_add_u32 v77, 73728, v9
    ds_read_b64_tr_b16 v[124:125], v77 offset:20480
    ds_read_b64_tr_b16 v[126:127], v77 offset:20992
    ds_read_b128 v[84:87], v76 offset:0
    ds_read_b128 v[88:91], v76 offset:4096
    ds_read_b128 v[92:95], v76 offset:8192
    ds_read_b128 v[96:99], v76 offset:12288
    ds_read_b128 v[100:103], v76 offset:16384
    ds_read_b64_tr_b16 v[128:129], v77 offset:24576
    ds_read_b64_tr_b16 v[130:131], v77 offset:25088
    v_xor_b32 v15, 64, v76
    ds_read_b128 v[104:107], v15 offset:0
    ds_read_b128 v[108:111], v15 offset:4096
    ds_read_b128 v[112:115], v15 offset:8192
    ds_read_b128 v[116:119], v15 offset:12288
    ds_read_b128 v[120:123], v15 offset:16384
    s_waitcnt lgkmcnt(7)
    v_mfma_f32_16x16x32_bf16 v[36:39], v[84:87], v[124:127], v[36:39]
    v_mfma_f32_16x16x32_bf16 v[40:43], v[88:91], v[124:127], v[40:43]
    v_mfma_f32_16x16x32_bf16 v[44:47], v[92:95], v[124:127], v[44:47]
    v_mfma_f32_16x16x32_bf16 v[48:51], v[96:99], v[124:127], v[48:51]
    v_mfma_f32_16x16x32_bf16 v[52:55], v[100:103], v[124:127], v[52:55]
    ds_read_b64_tr_b16 v[124:125], v77 offset:28672
    ds_read_b64_tr_b16 v[126:127], v77 offset:29184
    v_xor_b32 v15, 128, v76
    ds_read_b128 v[84:87], v15 offset:0
    ds_read_b128 v[88:91], v15 offset:4096
    ds_read_b128 v[92:95], v15 offset:8192
    ds_read_b128 v[96:99], v15 offset:12288
    ds_read_b128 v[100:103], v15 offset:16384
    s_waitcnt lgkmcnt(7)
    v_mfma_f32_16x16x32_bf16 v[36:39], v[104:107], v[128:131], v[36:39]
    v_mfma_f32_16x16x32_bf16 v[40:43], v[108:111], v[128:131], v[40:43]
    v_mfma_f32_16x16x32_bf16 v[44:47], v[112:115], v[128:131], v[44:47]
    v_mfma_f32_16x16x32_bf16 v[48:51], v[116:119], v[128:131], v[48:51]
    v_mfma_f32_16x16x32_bf16 v[52:55], v[120:123], v[128:131], v[52:55]
    ds_read_b64_tr_b16 v[128:129], v77 offset:32768
    ds_read_b64_tr_b16 v[130:131], v77 offset:33280
    v_xor_b32 v15, 192, v76
    ds_read_b128 v[104:107], v15 offset:0
    ds_read_b128 v[108:111], v15 offset:4096
    ds_read_b128 v[112:115], v15 offset:8192
    ds_read_b128 v[116:119], v15 offset:12288
    ds_read_b128 v[120:123], v15 offset:16384
    s_waitcnt lgkmcnt(7)
    v_mfma_f32_16x16x32_bf16 v[36:39], v[84:87], v[124:127], v[36:39]
    v_mfma_f32_16x16x32_bf16 v[40:43], v[88:91], v[124:127], v[40:43]
    v_mfma_f32_16x16x32_bf16 v[44:47], v[92:95], v[124:127], v[44:47]
    v_mfma_f32_16x16x32_bf16 v[48:51], v[96:99], v[124:127], v[48:51]
    v_mfma_f32_16x16x32_bf16 v[52:55], v[100:103], v[124:127], v[52:55]
    s_waitcnt lgkmcnt(0)
    v_mfma_f32_16x16x32_bf16 v[36:39], v[104:107], v[128:131], v[36:39]
    v_mfma_f32_16x16x32_bf16 v[40:43], v[108:111], v[128:131], v[40:43]
    v_mfma_f32_16x16x32_bf16 v[44:47], v[112:115], v[128:131], v[44:47]
    v_mfma_f32_16x16x32_bf16 v[48:51], v[116:119], v[128:131], v[48:51]
    v_mfma_f32_16x16x32_bf16 v[52:55], v[120:123], v[128:131], v[52:55]
    s_barrier
    v_add_u32 v76, 110592, v7
    v_add_u32 v77, 110592, v9
    ds_read_b64_tr_b16 v[124:125], v77 offset:20480
    ds_read_b64_tr_b16 v[126:127], v77 offset:20992
    ds_read_b128 v[84:87], v76 offset:0
    ds_read_b128 v[88:91], v76 offset:4096
    ds_read_b128 v[92:95], v76 offset:8192
    ds_read_b128 v[96:99], v76 offset:12288
    ds_read_b128 v[100:103], v76 offset:16384
    ds_read_b64_tr_b16 v[128:129], v77 offset:24576
    ds_read_b64_tr_b16 v[130:131], v77 offset:25088
    v_xor_b32 v15, 64, v76
    ds_read_b128 v[104:107], v15 offset:0
    ds_read_b128 v[108:111], v15 offset:4096
    ds_read_b128 v[112:115], v15 offset:8192
    ds_read_b128 v[116:119], v15 offset:12288
    ds_read_b128 v[120:123], v15 offset:16384
    s_waitcnt lgkmcnt(7)
    v_mfma_f32_16x16x32_bf16 v[36:39], v[84:87], v[124:127], v[36:39]
    v_mfma_f32_16x16x32_bf16 v[40:43], v[88:91], v[124:127], v[40:43]
    v_mfma_f32_16x16x32_bf16 v[44:47], v[92:95], v[124:127], v[44:47]
    v_mfma_f32_16x16x32_bf16 v[48:51], v[96:99], v[124:127], v[48:51]
    v_mfma_f32_16x16x32_bf16 v[52:55], v[100:103], v[124:127], v[52:55]
    ds_read_b64_tr_b16 v[124:125], v77 offset:28672
    ds_read_b64_tr_b16 v[126:127], v77 offset:29184
    v_xor_b32 v15, 128, v76
    ds_read_b128 v[84:87], v15 offset:0
    ds_read_b128 v[88:91], v15 offset:4096
    ds_read_b128 v[92:95], v15 offset:8192
    ds_read_b128 v[96:99], v15 offset:12288
    ds_read_b128 v[100:103], v15 offset:16384
    s_waitcnt lgkmcnt(7)
    v_mfma_f32_16x16x32_bf16 v[36:39], v[104:107], v[128:131], v[36:39]
    v_mfma_f32_16x16x32_bf16 v[40:43], v[108:111], v[128:131], v[40:43]
    v_mfma_f32_16x16x32_bf16 v[44:47], v[112:115], v[128:131], v[44:47]
    v_mfma_f32_16x16x32_bf16 v[48:51], v[116:119], v[128:131], v[48:51]
    v_mfma_f32_16x16x32_bf16 v[52:55], v[120:123], v[128:131], v[52:55]
    ds_read_b64_tr_b16 v[128:129], v77 offset:32768
    ds_read_b64_tr_b16 v[130:131], v77 offset:33280
    v_xor_b32 v15, 192, v76
    ds_read_b128 v[104:107], v15 offset:0
    ds_read_b128 v[108:111], v15 offset:4096
    ds_read_b128 v[112:115], v15 offset:8192
    ds_read_b128 v[116:119], v15 offset:12288
    ds_read_b128 v[120:123], v15 offset:16384
    s_waitcnt lgkmcnt(7)
    v_mfma_f32_16x16x32_bf16 v[36:39], v[84:87], v[124:127], v[36:39]
    v_mfma_f32_16x16x32_bf16 v[40:43], v[88:91], v[124:127], v[40:43]
    v_mfma_f32_16x16x32_bf16 v[44:47], v[92:95], v[124:127], v[44:47]
    v_mfma_f32_16x16x32_bf16 v[48:51], v[96:99], v[124:127], v[48:51]
    v_mfma_f32_16x16x32_bf16 v[52:55], v[100:103], v[124:127], v[52:55]
    s_waitcnt lgkmcnt(0)
    v_mfma_f32_16x16x32_bf16 v[36:39], v[104:107], v[128:131], v[36:39]
    v_mfma_f32_16x16x32_bf16 v[40:43], v[108:111], v[128:131], v[40:43]
    v_mfma_f32_16x16x32_bf16 v[44:47], v[112:115], v[128:131], v[44:47]
    v_mfma_f32_16x16x32_bf16 v[48:51], v[116:119], v[128:131], v[48:51]
    v_mfma_f32_16x16x32_bf16 v[52:55], v[120:123], v[128:131], v[52:55]
    s_barrier
    v_add_u32 v76, 0, v7
    v_add_u32 v77, 0, v9
    ds_read_b64_tr_b16 v[124:125], v77 offset:20480
    ds_read_b64_tr_b16 v[126:127], v77 offset:20992
    ds_read_b128 v[84:87], v76 offset:0
    ds_read_b128 v[88:91], v76 offset:4096
    ds_read_b128 v[92:95], v76 offset:8192
    ds_read_b128 v[96:99], v76 offset:12288
    ds_read_b128 v[100:103], v76 offset:16384
    ds_read_b64_tr_b16 v[128:129], v77 offset:24576
    ds_read_b64_tr_b16 v[130:131], v77 offset:25088
    v_xor_b32 v15, 64, v76
    ds_read_b128 v[104:107], v15 offset:0
    ds_read_b128 v[108:111], v15 offset:4096
    ds_read_b128 v[112:115], v15 offset:8192
    ds_read_b128 v[116:119], v15 offset:12288
    ds_read_b128 v[120:123], v15 offset:16384
    s_waitcnt lgkmcnt(7)
    v_mfma_f32_16x16x32_bf16 v[36:39], v[84:87], v[124:127], v[36:39]
    v_mfma_f32_16x16x32_bf16 v[40:43], v[88:91], v[124:127], v[40:43]
    v_mfma_f32_16x16x32_bf16 v[44:47], v[92:95], v[124:127], v[44:47]
    v_mfma_f32_16x16x32_bf16 v[48:51], v[96:99], v[124:127], v[48:51]
    v_mfma_f32_16x16x32_bf16 v[52:55], v[100:103], v[124:127], v[52:55]
    ds_read_b64_tr_b16 v[124:125], v77 offset:28672
    ds_read_b64_tr_b16 v[126:127], v77 offset:29184
    v_xor_b32 v15, 128, v76
    ds_read_b128 v[84:87], v15 offset:0
    ds_read_b128 v[88:91], v15 offset:4096
    ds_read_b128 v[92:95], v15 offset:8192
    ds_read_b128 v[96:99], v15 offset:12288
    ds_read_b128 v[100:103], v15 offset:16384
    s_waitcnt lgkmcnt(7)
    v_mfma_f32_16x16x32_bf16 v[36:39], v[104:107], v[128:131], v[36:39]
    v_mfma_f32_16x16x32_bf16 v[40:43], v[108:111], v[128:131], v[40:43]
    v_mfma_f32_16x16x32_bf16 v[44:47], v[112:115], v[128:131], v[44:47]
    v_mfma_f32_16x16x32_bf16 v[48:51], v[116:119], v[128:131], v[48:51]
    v_mfma_f32_16x16x32_bf16 v[52:55], v[120:123], v[128:131], v[52:55]
    ds_read_b64_tr_b16 v[128:129], v77 offset:32768
    ds_read_b64_tr_b16 v[130:131], v77 offset:33280
    v_xor_b32 v15, 192, v76
    ds_read_b128 v[104:107], v15 offset:0
    ds_read_b128 v[108:111], v15 offset:4096
    ds_read_b128 v[112:115], v15 offset:8192
    ds_read_b128 v[116:119], v15 offset:12288
    ds_read_b128 v[120:123], v15 offset:16384
    s_waitcnt lgkmcnt(7)
    v_mfma_f32_16x16x32_bf16 v[36:39], v[84:87], v[124:127], v[36:39]
    v_mfma_f32_16x16x32_bf16 v[40:43], v[88:91], v[124:127], v[40:43]
    v_mfma_f32_16x16x32_bf16 v[44:47], v[92:95], v[124:127], v[44:47]
    v_mfma_f32_16x16x32_bf16 v[48:51], v[96:99], v[124:127], v[48:51]
    v_mfma_f32_16x16x32_bf16 v[52:55], v[100:103], v[124:127], v[52:55]
    s_waitcnt lgkmcnt(0)
    v_mfma_f32_16x16x32_bf16 v[36:39], v[104:107], v[128:131], v[36:39]
    v_mfma_f32_16x16x32_bf16 v[40:43], v[108:111], v[128:131], v[40:43]
    v_mfma_f32_16x16x32_bf16 v[44:47], v[112:115], v[128:131], v[44:47]
    v_mfma_f32_16x16x32_bf16 v[48:51], v[116:119], v[128:131], v[48:51]
    v_mfma_f32_16x16x32_bf16 v[52:55], v[120:123], v[128:131], v[52:55]
    s_barrier
    v_add_u32 v76, 36864, v7
    v_add_u32 v77, 36864, v9
    ds_read_b64_tr_b16 v[124:125], v77 offset:20480
    ds_read_b64_tr_b16 v[126:127], v77 offset:20992
    ds_read_b128 v[84:87], v76 offset:0
    ds_read_b128 v[88:91], v76 offset:4096
    ds_read_b128 v[92:95], v76 offset:8192
    ds_read_b128 v[96:99], v76 offset:12288
    ds_read_b128 v[100:103], v76 offset:16384
    ds_read_b64_tr_b16 v[128:129], v77 offset:24576
    ds_read_b64_tr_b16 v[130:131], v77 offset:25088
    v_xor_b32 v15, 64, v76
    ds_read_b128 v[104:107], v15 offset:0
    ds_read_b128 v[108:111], v15 offset:4096
    ds_read_b128 v[112:115], v15 offset:8192
    ds_read_b128 v[116:119], v15 offset:12288
    ds_read_b128 v[120:123], v15 offset:16384
    s_waitcnt lgkmcnt(7)
    v_mfma_f32_16x16x32_bf16 v[36:39], v[84:87], v[124:127], v[36:39]
    v_mfma_f32_16x16x32_bf16 v[40:43], v[88:91], v[124:127], v[40:43]
    v_mfma_f32_16x16x32_bf16 v[44:47], v[92:95], v[124:127], v[44:47]
    v_mfma_f32_16x16x32_bf16 v[48:51], v[96:99], v[124:127], v[48:51]
    v_mfma_f32_16x16x32_bf16 v[52:55], v[100:103], v[124:127], v[52:55]
    ds_read_b64_tr_b16 v[124:125], v77 offset:28672
    ds_read_b64_tr_b16 v[126:127], v77 offset:29184
    v_xor_b32 v15, 128, v76
    ds_read_b128 v[84:87], v15 offset:0
    ds_read_b128 v[88:91], v15 offset:4096
    ds_read_b128 v[92:95], v15 offset:8192
    ds_read_b128 v[96:99], v15 offset:12288
    ds_read_b128 v[100:103], v15 offset:16384
    s_waitcnt lgkmcnt(7)
    v_mfma_f32_16x16x32_bf16 v[36:39], v[104:107], v[128:131], v[36:39]
    v_mfma_f32_16x16x32_bf16 v[40:43], v[108:111], v[128:131], v[40:43]
    v_mfma_f32_16x16x32_bf16 v[44:47], v[112:115], v[128:131], v[44:47]
    v_mfma_f32_16x16x32_bf16 v[48:51], v[116:119], v[128:131], v[48:51]
    v_mfma_f32_16x16x32_bf16 v[52:55], v[120:123], v[128:131], v[52:55]
    ds_read_b64_tr_b16 v[128:129], v77 offset:32768
    ds_read_b64_tr_b16 v[130:131], v77 offset:33280
    v_xor_b32 v15, 192, v76
    ds_read_b128 v[104:107], v15 offset:0
    ds_read_b128 v[108:111], v15 offset:4096
    ds_read_b128 v[112:115], v15 offset:8192
    ds_read_b128 v[116:119], v15 offset:12288
    ds_read_b128 v[120:123], v15 offset:16384
    s_waitcnt lgkmcnt(7)
    v_mfma_f32_16x16x32_bf16 v[36:39], v[84:87], v[124:127], v[36:39]
    v_mfma_f32_16x16x32_bf16 v[40:43], v[88:91], v[124:127], v[40:43]
    v_mfma_f32_16x16x32_bf16 v[44:47], v[92:95], v[124:127], v[44:47]
    v_mfma_f32_16x16x32_bf16 v[48:51], v[96:99], v[124:127], v[48:51]
    v_mfma_f32_16x16x32_bf16 v[52:55], v[100:103], v[124:127], v[52:55]
    s_waitcnt lgkmcnt(0)
    v_mfma_f32_16x16x32_bf16 v[36:39], v[104:107], v[128:131], v[36:39]
    v_mfma_f32_16x16x32_bf16 v[40:43], v[108:111], v[128:131], v[40:43]
    v_mfma_f32_16x16x32_bf16 v[44:47], v[112:115], v[128:131], v[44:47]
    v_mfma_f32_16x16x32_bf16 v[48:51], v[116:119], v[128:131], v[48:51]
    v_mfma_f32_16x16x32_bf16 v[52:55], v[120:123], v[128:131], v[52:55]
    s_barrier
    v_add_u32 v76, 73728, v7
    v_add_u32 v77, 73728, v9
    ds_read_b64_tr_b16 v[124:125], v77 offset:20480
    ds_read_b64_tr_b16 v[126:127], v77 offset:20992
    ds_read_b128 v[84:87], v76 offset:0
    ds_read_b128 v[88:91], v76 offset:4096
    ds_read_b128 v[92:95], v76 offset:8192
    ds_read_b128 v[96:99], v76 offset:12288
    ds_read_b128 v[100:103], v76 offset:16384
    ds_read_b64_tr_b16 v[128:129], v77 offset:24576
    ds_read_b64_tr_b16 v[130:131], v77 offset:25088
    v_xor_b32 v15, 64, v76
    ds_read_b128 v[104:107], v15 offset:0
    ds_read_b128 v[108:111], v15 offset:4096
    ds_read_b128 v[112:115], v15 offset:8192
    ds_read_b128 v[116:119], v15 offset:12288
    ds_read_b128 v[120:123], v15 offset:16384
    s_waitcnt lgkmcnt(7)
    v_mfma_f32_16x16x32_bf16 v[36:39], v[84:87], v[124:127], v[36:39]
    v_mfma_f32_16x16x32_bf16 v[40:43], v[88:91], v[124:127], v[40:43]
    v_mfma_f32_16x16x32_bf16 v[44:47], v[92:95], v[124:127], v[44:47]
    v_mfma_f32_16x16x32_bf16 v[48:51], v[96:99], v[124:127], v[48:51]
    v_mfma_f32_16x16x32_bf16 v[52:55], v[100:103], v[124:127], v[52:55]
    ds_read_b64_tr_b16 v[124:125], v77 offset:28672
    ds_read_b64_tr_b16 v[126:127], v77 offset:29184
    v_xor_b32 v15, 128, v76
    ds_read_b128 v[84:87], v15 offset:0
    ds_read_b128 v[88:91], v15 offset:4096
    ds_read_b128 v[92:95], v15 offset:8192
    ds_read_b128 v[96:99], v15 offset:12288
    ds_read_b128 v[100:103], v15 offset:16384
    s_waitcnt lgkmcnt(7)
    v_mfma_f32_16x16x32_bf16 v[36:39], v[104:107], v[128:131], v[36:39]
    v_mfma_f32_16x16x32_bf16 v[40:43], v[108:111], v[128:131], v[40:43]
    v_mfma_f32_16x16x32_bf16 v[44:47], v[112:115], v[128:131], v[44:47]
    v_mfma_f32_16x16x32_bf16 v[48:51], v[116:119], v[128:131], v[48:51]
    v_mfma_f32_16x16x32_bf16 v[52:55], v[120:123], v[128:131], v[52:55]
    ds_read_b64_tr_b16 v[128:129], v77 offset:32768
    ds_read_b64_tr_b16 v[130:131], v77 offset:33280
    v_xor_b32 v15, 192, v76
    ds_read_b128 v[104:107], v15 offset:0
    ds_read_b128 v[108:111], v15 offset:4096
    ds_read_b128 v[112:115], v15 offset:8192
    ds_read_b128 v[116:119], v15 offset:12288
    ds_read_b128 v[120:123], v15 offset:16384
    s_waitcnt lgkmcnt(7)
    v_mfma_f32_16x16x32_bf16 v[36:39], v[84:87], v[124:127], v[36:39]
    v_mfma_f32_16x16x32_bf16 v[40:43], v[88:91], v[124:127], v[40:43]
    v_mfma_f32_16x16x32_bf16 v[44:47], v[92:95], v[124:127], v[44:47]
    v_mfma_f32_16x16x32_bf16 v[48:51], v[96:99], v[124:127], v[48:51]
    v_mfma_f32_16x16x32_bf16 v[52:55], v[100:103], v[124:127], v[52:55]
    s_waitcnt lgkmcnt(0)
    v_mfma_f32_16x16x32_bf16 v[36:39], v[104:107], v[128:131], v[36:39]
    v_mfma_f32_16x16x32_bf16 v[40:43], v[108:111], v[128:131], v[40:43]
    v_mfma_f32_16x16x32_bf16 v[44:47], v[112:115], v[128:131], v[44:47]
    v_mfma_f32_16x16x32_bf16 v[48:51], v[116:119], v[128:131], v[48:51]
    v_mfma_f32_16x16x32_bf16 v[52:55], v[120:123], v[128:131], v[52:55]
    s_barrier
    v_add_u32 v76, 110592, v7
    v_add_u32 v77, 110592, v9
    ds_read_b64_tr_b16 v[124:125], v77 offset:20480
    ds_read_b64_tr_b16 v[126:127], v77 offset:20992
    ds_read_b128 v[84:87], v76 offset:0
    ds_read_b128 v[88:91], v76 offset:4096
    ds_read_b128 v[92:95], v76 offset:8192
    ds_read_b128 v[96:99], v76 offset:12288
    ds_read_b128 v[100:103], v76 offset:16384
    ds_read_b64_tr_b16 v[128:129], v77 offset:24576
    ds_read_b64_tr_b16 v[130:131], v77 offset:25088
    v_xor_b32 v15, 64, v76
    ds_read_b128 v[104:107], v15 offset:0
    ds_read_b128 v[108:111], v15 offset:4096
    ds_read_b128 v[112:115], v15 offset:8192
    ds_read_b128 v[116:119], v15 offset:12288
    ds_read_b128 v[120:123], v15 offset:16384
    s_waitcnt lgkmcnt(7)
    v_mfma_f32_16x16x32_bf16 v[36:39], v[84:87], v[124:127], v[36:39]
    v_mfma_f32_16x16x32_bf16 v[40:43], v[88:91], v[124:127], v[40:43]
    v_mfma_f32_16x16x32_bf16 v[44:47], v[92:95], v[124:127], v[44:47]
    v_mfma_f32_16x16x32_bf16 v[48:51], v[96:99], v[124:127], v[48:51]
    v_mfma_f32_16x16x32_bf16 v[52:55], v[100:103], v[124:127], v[52:55]
    ds_read_b64_tr_b16 v[124:125], v77 offset:28672
    ds_read_b64_tr_b16 v[126:127], v77 offset:29184
    v_xor_b32 v15, 128, v76
    ds_read_b128 v[84:87], v15 offset:0
    ds_read_b128 v[88:91], v15 offset:4096
    ds_read_b128 v[92:95], v15 offset:8192
    ds_read_b128 v[96:99], v15 offset:12288
    ds_read_b128 v[100:103], v15 offset:16384
    s_waitcnt lgkmcnt(7)
    v_mfma_f32_16x16x32_bf16 v[36:39], v[104:107], v[128:131], v[36:39]
    v_mfma_f32_16x16x32_bf16 v[40:43], v[108:111], v[128:131], v[40:43]
    v_mfma_f32_16x16x32_bf16 v[44:47], v[112:115], v[128:131], v[44:47]
    v_mfma_f32_16x16x32_bf16 v[48:51], v[116:119], v[128:131], v[48:51]
    v_mfma_f32_16x16x32_bf16 v[52:55], v[120:123], v[128:131], v[52:55]
    ds_read_b64_tr_b16 v[128:129], v77 offset:32768
    ds_read_b64_tr_b16 v[130:131], v77 offset:33280
    v_xor_b32 v15, 192, v76
    ds_read_b128 v[104:107], v15 offset:0
    ds_read_b128 v[108:111], v15 offset:4096
    ds_read_b128 v[112:115], v15 offset:8192
    ds_read_b128 v[116:119], v15 offset:12288
    ds_read_b128 v[120:123], v15 offset:16384
    s_waitcnt lgkmcnt(7)
    v_mfma_f32_16x16x32_bf16 v[36:39], v[84:87], v[124:127], v[36:39]
    v_mfma_f32_16x16x32_bf16 v[40:43], v[88:91], v[124:127], v[40:43]
    v_mfma_f32_16x16x32_bf16 v[44:47], v[92:95], v[124:127], v[44:47]
    v_mfma_f32_16x16x32_bf16 v[48:51], v[96:99], v[124:127], v[48:51]
    v_mfma_f32_16x16x32_bf16 v[52:55], v[100:103], v[124:127], v[52:55]
    s_waitcnt lgkmcnt(0)
    v_mfma_f32_16x16x32_bf16 v[36:39], v[104:107], v[128:131], v[36:39]
    v_mfma_f32_16x16x32_bf16 v[40:43], v[108:111], v[128:131], v[40:43]
    v_mfma_f32_16x16x32_bf16 v[44:47], v[112:115], v[128:131], v[44:47]
    v_mfma_f32_16x16x32_bf16 v[48:51], v[116:119], v[128:131], v[48:51]
    v_mfma_f32_16x16x32_bf16 v[52:55], v[120:123], v[128:131], v[52:55]
    s_barrier
    v_add_u32 v76, 0, v7
    v_add_u32 v77, 0, v9
    ds_read_b64_tr_b16 v[124:125], v77 offset:20480
    ds_read_b64_tr_b16 v[126:127], v77 offset:20992
    ds_read_b128 v[84:87], v76 offset:0
    ds_read_b128 v[88:91], v76 offset:4096
    ds_read_b128 v[92:95], v76 offset:8192
    ds_read_b128 v[96:99], v76 offset:12288
    ds_read_b128 v[100:103], v76 offset:16384
    ds_read_b64_tr_b16 v[128:129], v77 offset:24576
    ds_read_b64_tr_b16 v[130:131], v77 offset:25088
    v_xor_b32 v15, 64, v76
    ds_read_b128 v[104:107], v15 offset:0
    ds_read_b128 v[108:111], v15 offset:4096
    ds_read_b128 v[112:115], v15 offset:8192
    ds_read_b128 v[116:119], v15 offset:12288
    ds_read_b128 v[120:123], v15 offset:16384
    s_waitcnt lgkmcnt(7)
    v_mfma_f32_16x16x32_bf16 v[36:39], v[84:87], v[124:127], v[36:39]
    v_mfma_f32_16x16x32_bf16 v[40:43], v[88:91], v[124:127], v[40:43]
    v_mfma_f32_16x16x32_bf16 v[44:47], v[92:95], v[124:127], v[44:47]
    v_mfma_f32_16x16x32_bf16 v[48:51], v[96:99], v[124:127], v[48:51]
    v_mfma_f32_16x16x32_bf16 v[52:55], v[100:103], v[124:127], v[52:55]
    ds_read_b64_tr_b16 v[124:125], v77 offset:28672
    ds_read_b64_tr_b16 v[126:127], v77 offset:29184
    v_xor_b32 v15, 128, v76
    ds_read_b128 v[84:87], v15 offset:0
    ds_read_b128 v[88:91], v15 offset:4096
    ds_read_b128 v[92:95], v15 offset:8192
    ds_read_b128 v[96:99], v15 offset:12288
    ds_read_b128 v[100:103], v15 offset:16384
    s_waitcnt lgkmcnt(7)
    v_mfma_f32_16x16x32_bf16 v[36:39], v[104:107], v[128:131], v[36:39]
    v_mfma_f32_16x16x32_bf16 v[40:43], v[108:111], v[128:131], v[40:43]
    v_mfma_f32_16x16x32_bf16 v[44:47], v[112:115], v[128:131], v[44:47]
    v_mfma_f32_16x16x32_bf16 v[48:51], v[116:119], v[128:131], v[48:51]
    v_mfma_f32_16x16x32_bf16 v[52:55], v[120:123], v[128:131], v[52:55]
    ds_read_b64_tr_b16 v[128:129], v77 offset:32768
    ds_read_b64_tr_b16 v[130:131], v77 offset:33280
    v_xor_b32 v15, 192, v76
    ds_read_b128 v[104:107], v15 offset:0
    ds_read_b128 v[108:111], v15 offset:4096
    ds_read_b128 v[112:115], v15 offset:8192
    ds_read_b128 v[116:119], v15 offset:12288
    ds_read_b128 v[120:123], v15 offset:16384
    s_waitcnt lgkmcnt(7)
    v_mfma_f32_16x16x32_bf16 v[36:39], v[84:87], v[124:127], v[36:39]
    v_mfma_f32_16x16x32_bf16 v[40:43], v[88:91], v[124:127], v[40:43]
    v_mfma_f32_16x16x32_bf16 v[44:47], v[92:95], v[124:127], v[44:47]
    v_mfma_f32_16x16x32_bf16 v[48:51], v[96:99], v[124:127], v[48:51]
    v_mfma_f32_16x16x32_bf16 v[52:55], v[100:103], v[124:127], v[52:55]
    s_waitcnt lgkmcnt(0)
    v_mfma_f32_16x16x32_bf16 v[36:39], v[104:107], v[128:131], v[36:39]
    v_mfma_f32_16x16x32_bf16 v[40:43], v[108:111], v[128:131], v[40:43]
    v_mfma_f32_16x16x32_bf16 v[44:47], v[112:115], v[128:131], v[44:47]
    v_mfma_f32_16x16x32_bf16 v[48:51], v[116:119], v[128:131], v[48:51]
    v_mfma_f32_16x16x32_bf16 v[52:55], v[120:123], v[128:131], v[52:55]
    s_barrier
    v_add_u32 v76, 36864, v7
    v_add_u32 v77, 36864, v9
    ds_read_b64_tr_b16 v[124:125], v77 offset:20480
    ds_read_b64_tr_b16 v[126:127], v77 offset:20992
    ds_read_b128 v[84:87], v76 offset:0
    ds_read_b128 v[88:91], v76 offset:4096
    ds_read_b128 v[92:95], v76 offset:8192
    ds_read_b128 v[96:99], v76 offset:12288
    ds_read_b128 v[100:103], v76 offset:16384
    ds_read_b64_tr_b16 v[128:129], v77 offset:24576
    ds_read_b64_tr_b16 v[130:131], v77 offset:25088
    v_xor_b32 v15, 64, v76
    ds_read_b128 v[104:107], v15 offset:0
    ds_read_b128 v[108:111], v15 offset:4096
    ds_read_b128 v[112:115], v15 offset:8192
    ds_read_b128 v[116:119], v15 offset:12288
    ds_read_b128 v[120:123], v15 offset:16384
    s_waitcnt lgkmcnt(7)
    v_mfma_f32_16x16x32_bf16 v[36:39], v[84:87], v[124:127], v[36:39]
    v_mfma_f32_16x16x32_bf16 v[40:43], v[88:91], v[124:127], v[40:43]
    v_mfma_f32_16x16x32_bf16 v[44:47], v[92:95], v[124:127], v[44:47]
    v_mfma_f32_16x16x32_bf16 v[48:51], v[96:99], v[124:127], v[48:51]
    v_mfma_f32_16x16x32_bf16 v[52:55], v[100:103], v[124:127], v[52:55]
    ds_read_b64_tr_b16 v[124:125], v77 offset:28672
    ds_read_b64_tr_b16 v[126:127], v77 offset:29184
    v_xor_b32 v15, 128, v76
    ds_read_b128 v[84:87], v15 offset:0
    ds_read_b128 v[88:91], v15 offset:4096
    ds_read_b128 v[92:95], v15 offset:8192
    ds_read_b128 v[96:99], v15 offset:12288
    ds_read_b128 v[100:103], v15 offset:16384
    s_waitcnt lgkmcnt(7)
    v_mfma_f32_16x16x32_bf16 v[36:39], v[104:107], v[128:131], v[36:39]
    v_mfma_f32_16x16x32_bf16 v[40:43], v[108:111], v[128:131], v[40:43]
    v_mfma_f32_16x16x32_bf16 v[44:47], v[112:115], v[128:131], v[44:47]
    v_mfma_f32_16x16x32_bf16 v[48:51], v[116:119], v[128:131], v[48:51]
    v_mfma_f32_16x16x32_bf16 v[52:55], v[120:123], v[128:131], v[52:55]
    ds_read_b64_tr_b16 v[128:129], v77 offset:32768
    ds_read_b64_tr_b16 v[130:131], v77 offset:33280
    v_xor_b32 v15, 192, v76
    ds_read_b128 v[104:107], v15 offset:0
    ds_read_b128 v[108:111], v15 offset:4096
    ds_read_b128 v[112:115], v15 offset:8192
    ds_read_b128 v[116:119], v15 offset:12288
    ds_read_b128 v[120:123], v15 offset:16384
    s_waitcnt lgkmcnt(7)
    v_mfma_f32_16x16x32_bf16 v[36:39], v[84:87], v[124:127], v[36:39]
    v_mfma_f32_16x16x32_bf16 v[40:43], v[88:91], v[124:127], v[40:43]
    v_mfma_f32_16x16x32_bf16 v[44:47], v[92:95], v[124:127], v[44:47]
    v_mfma_f32_16x16x32_bf16 v[48:51], v[96:99], v[124:127], v[48:51]
    v_mfma_f32_16x16x32_bf16 v[52:55], v[100:103], v[124:127], v[52:55]
    s_waitcnt lgkmcnt(0)
    v_mfma_f32_16x16x32_bf16 v[36:39], v[104:107], v[128:131], v[36:39]
    v_mfma_f32_16x16x32_bf16 v[40:43], v[108:111], v[128:131], v[40:43]
    v_mfma_f32_16x16x32_bf16 v[44:47], v[112:115], v[128:131], v[44:47]
    v_mfma_f32_16x16x32_bf16 v[48:51], v[116:119], v[128:131], v[48:51]
    v_mfma_f32_16x16x32_bf16 v[52:55], v[120:123], v[128:131], v[52:55]
    s_barrier
    v_add_u32 v76, 73728, v7
    v_add_u32 v77, 73728, v9
    ds_read_b64_tr_b16 v[124:125], v77 offset:20480
    ds_read_b64_tr_b16 v[126:127], v77 offset:20992
    ds_read_b128 v[84:87], v76 offset:0
    ds_read_b128 v[88:91], v76 offset:4096
    ds_read_b128 v[92:95], v76 offset:8192
    ds_read_b128 v[96:99], v76 offset:12288
    ds_read_b128 v[100:103], v76 offset:16384
    ds_read_b64_tr_b16 v[128:129], v77 offset:24576
    ds_read_b64_tr_b16 v[130:131], v77 offset:25088
    v_xor_b32 v15, 64, v76
    ds_read_b128 v[104:107], v15 offset:0
    ds_read_b128 v[108:111], v15 offset:4096
    ds_read_b128 v[112:115], v15 offset:8192
    ds_read_b128 v[116:119], v15 offset:12288
    ds_read_b128 v[120:123], v15 offset:16384
    s_waitcnt lgkmcnt(7)
    v_mfma_f32_16x16x32_bf16 v[36:39], v[84:87], v[124:127], v[36:39]
    v_mfma_f32_16x16x32_bf16 v[40:43], v[88:91], v[124:127], v[40:43]
    v_mfma_f32_16x16x32_bf16 v[44:47], v[92:95], v[124:127], v[44:47]
    v_mfma_f32_16x16x32_bf16 v[48:51], v[96:99], v[124:127], v[48:51]
    v_mfma_f32_16x16x32_bf16 v[52:55], v[100:103], v[124:127], v[52:55]
    ds_read_b64_tr_b16 v[124:125], v77 offset:28672
    ds_read_b64_tr_b16 v[126:127], v77 offset:29184
    v_xor_b32 v15, 128, v76
    ds_read_b128 v[84:87], v15 offset:0
    ds_read_b128 v[88:91], v15 offset:4096
    ds_read_b128 v[92:95], v15 offset:8192
    ds_read_b128 v[96:99], v15 offset:12288
    ds_read_b128 v[100:103], v15 offset:16384
    s_waitcnt lgkmcnt(7)
    v_mfma_f32_16x16x32_bf16 v[36:39], v[104:107], v[128:131], v[36:39]
    v_mfma_f32_16x16x32_bf16 v[40:43], v[108:111], v[128:131], v[40:43]
    v_mfma_f32_16x16x32_bf16 v[44:47], v[112:115], v[128:131], v[44:47]
    v_mfma_f32_16x16x32_bf16 v[48:51], v[116:119], v[128:131], v[48:51]
    v_mfma_f32_16x16x32_bf16 v[52:55], v[120:123], v[128:131], v[52:55]
    ds_read_b64_tr_b16 v[128:129], v77 offset:32768
    ds_read_b64_tr_b16 v[130:131], v77 offset:33280
    v_xor_b32 v15, 192, v76
    ds_read_b128 v[104:107], v15 offset:0
    ds_read_b128 v[108:111], v15 offset:4096
    ds_read_b128 v[112:115], v15 offset:8192
    ds_read_b128 v[116:119], v15 offset:12288
    ds_read_b128 v[120:123], v15 offset:16384
    s_waitcnt lgkmcnt(7)
    v_mfma_f32_16x16x32_bf16 v[36:39], v[84:87], v[124:127], v[36:39]
    v_mfma_f32_16x16x32_bf16 v[40:43], v[88:91], v[124:127], v[40:43]
    v_mfma_f32_16x16x32_bf16 v[44:47], v[92:95], v[124:127], v[44:47]
    v_mfma_f32_16x16x32_bf16 v[48:51], v[96:99], v[124:127], v[48:51]
    v_mfma_f32_16x16x32_bf16 v[52:55], v[100:103], v[124:127], v[52:55]
    s_waitcnt lgkmcnt(0)
    v_mfma_f32_16x16x32_bf16 v[36:39], v[104:107], v[128:131], v[36:39]
    v_mfma_f32_16x16x32_bf16 v[40:43], v[108:111], v[128:131], v[40:43]
    v_mfma_f32_16x16x32_bf16 v[44:47], v[112:115], v[128:131], v[44:47]
    v_mfma_f32_16x16x32_bf16 v[48:51], v[116:119], v[128:131], v[48:51]
    v_mfma_f32_16x16x32_bf16 v[52:55], v[120:123], v[128:131], v[52:55]
    s_barrier
    v_add_u32 v76, 110592, v7
    v_add_u32 v77, 110592, v9
    ds_read_b64_tr_b16 v[124:125], v77 offset:20480
    ds_read_b64_tr_b16 v[126:127], v77 offset:20992
    ds_read_b128 v[84:87], v76 offset:0
    ds_read_b128 v[88:91], v76 offset:4096
    ds_read_b128 v[92:95], v76 offset:8192
    ds_read_b128 v[96:99], v76 offset:12288
    ds_read_b128 v[100:103], v76 offset:16384
    ds_read_b64_tr_b16 v[128:129], v77 offset:24576
    ds_read_b64_tr_b16 v[130:131], v77 offset:25088
    v_xor_b32 v15, 64, v76
    ds_read_b128 v[104:107], v15 offset:0
    ds_read_b128 v[108:111], v15 offset:4096
    ds_read_b128 v[112:115], v15 offset:8192
    ds_read_b128 v[116:119], v15 offset:12288
    ds_read_b128 v[120:123], v15 offset:16384
    s_waitcnt lgkmcnt(7)
    v_mfma_f32_16x16x32_bf16 v[36:39], v[84:87], v[124:127], v[36:39]
    v_mfma_f32_16x16x32_bf16 v[40:43], v[88:91], v[124:127], v[40:43]
    v_mfma_f32_16x16x32_bf16 v[44:47], v[92:95], v[124:127], v[44:47]
    v_mfma_f32_16x16x32_bf16 v[48:51], v[96:99], v[124:127], v[48:51]
    v_mfma_f32_16x16x32_bf16 v[52:55], v[100:103], v[124:127], v[52:55]
    ds_read_b64_tr_b16 v[124:125], v77 offset:28672
    ds_read_b64_tr_b16 v[126:127], v77 offset:29184
    v_xor_b32 v15, 128, v76
    ds_read_b128 v[84:87], v15 offset:0
    ds_read_b128 v[88:91], v15 offset:4096
    ds_read_b128 v[92:95], v15 offset:8192
    ds_read_b128 v[96:99], v15 offset:12288
    ds_read_b128 v[100:103], v15 offset:16384
    s_waitcnt lgkmcnt(7)
    v_mfma_f32_16x16x32_bf16 v[36:39], v[104:107], v[128:131], v[36:39]
    v_mfma_f32_16x16x32_bf16 v[40:43], v[108:111], v[128:131], v[40:43]
    v_mfma_f32_16x16x32_bf16 v[44:47], v[112:115], v[128:131], v[44:47]
    v_mfma_f32_16x16x32_bf16 v[48:51], v[116:119], v[128:131], v[48:51]
    v_mfma_f32_16x16x32_bf16 v[52:55], v[120:123], v[128:131], v[52:55]
    ds_read_b64_tr_b16 v[128:129], v77 offset:32768
    ds_read_b64_tr_b16 v[130:131], v77 offset:33280
    v_xor_b32 v15, 192, v76
    ds_read_b128 v[104:107], v15 offset:0
    ds_read_b128 v[108:111], v15 offset:4096
    ds_read_b128 v[112:115], v15 offset:8192
    ds_read_b128 v[116:119], v15 offset:12288
    ds_read_b128 v[120:123], v15 offset:16384
    s_waitcnt lgkmcnt(7)
    v_mfma_f32_16x16x32_bf16 v[36:39], v[84:87], v[124:127], v[36:39]
    v_mfma_f32_16x16x32_bf16 v[40:43], v[88:91], v[124:127], v[40:43]
    v_mfma_f32_16x16x32_bf16 v[44:47], v[92:95], v[124:127], v[44:47]
    v_mfma_f32_16x16x32_bf16 v[48:51], v[96:99], v[124:127], v[48:51]
    v_mfma_f32_16x16x32_bf16 v[52:55], v[100:103], v[124:127], v[52:55]
    s_waitcnt lgkmcnt(0)
    v_mfma_f32_16x16x32_bf16 v[36:39], v[104:107], v[128:131], v[36:39]
    v_mfma_f32_16x16x32_bf16 v[40:43], v[108:111], v[128:131], v[40:43]
    v_mfma_f32_16x16x32_bf16 v[44:47], v[112:115], v[128:131], v[44:47]
    v_mfma_f32_16x16x32_bf16 v[48:51], v[116:119], v[128:131], v[48:51]
    v_mfma_f32_16x16x32_bf16 v[52:55], v[120:123], v[128:131], v[52:55]
    s_barrier
    v_add_u32 v76, 0, v6
    v_add_u32 v77, 0, v8
    ds_read_b128 v[124:127], v77 offset:20480
    ds_read_b64_tr_b16 v[84:85], v76 offset:0
    ds_read_b64_tr_b16 v[86:87], v76 offset:1280
    ds_read_b64_tr_b16 v[88:89], v76 offset:32
    ds_read_b64_tr_b16 v[90:91], v76 offset:1312
    ds_read_b64_tr_b16 v[92:93], v76 offset:64
    ds_read_b64_tr_b16 v[94:95], v76 offset:1344
    ds_read_b64_tr_b16 v[96:97], v76 offset:96
    ds_read_b64_tr_b16 v[98:99], v76 offset:1376
    ds_read_b64_tr_b16 v[100:101], v76 offset:128
    ds_read_b64_tr_b16 v[102:103], v76 offset:1408
    v_xor_b32 v15, 64, v77
    ds_read_b128 v[128:131], v15 offset:20480
    ds_read_b64_tr_b16 v[104:105], v76 offset:5120
    ds_read_b64_tr_b16 v[106:107], v76 offset:6400
    ds_read_b64_tr_b16 v[108:109], v76 offset:5152
    ds_read_b64_tr_b16 v[110:111], v76 offset:6432
    ds_read_b64_tr_b16 v[112:113], v76 offset:5184
    ds_read_b64_tr_b16 v[114:115], v76 offset:6464
    ds_read_b64_tr_b16 v[116:117], v76 offset:5216
    ds_read_b64_tr_b16 v[118:119], v76 offset:6496
    ds_read_b64_tr_b16 v[120:121], v76 offset:5248
    ds_read_b64_tr_b16 v[122:123], v76 offset:6528
    s_waitcnt lgkmcnt(11)
    v_mfma_f32_16x16x32_bf16 v[16:19], v[84:87], v[124:127], 0
    v_mfma_f32_16x16x32_bf16 v[20:23], v[88:91], v[124:127], 0
    v_mfma_f32_16x16x32_bf16 v[24:27], v[92:95], v[124:127], 0
    v_mfma_f32_16x16x32_bf16 v[28:31], v[96:99], v[124:127], 0
    v_mfma_f32_16x16x32_bf16 v[32:35], v[100:103], v[124:127], 0
    v_xor_b32 v15, 128, v77
    ds_read_b128 v[124:127], v15 offset:20480
    ds_read_b64_tr_b16 v[84:85], v76 offset:10240
    ds_read_b64_tr_b16 v[86:87], v76 offset:11520
    ds_read_b64_tr_b16 v[88:89], v76 offset:10272
    ds_read_b64_tr_b16 v[90:91], v76 offset:11552
    ds_read_b64_tr_b16 v[92:93], v76 offset:10304
    ds_read_b64_tr_b16 v[94:95], v76 offset:11584
    ds_read_b64_tr_b16 v[96:97], v76 offset:10336
    ds_read_b64_tr_b16 v[98:99], v76 offset:11616
    ds_read_b64_tr_b16 v[100:101], v76 offset:10368
    ds_read_b64_tr_b16 v[102:103], v76 offset:11648
    s_waitcnt lgkmcnt(11)
    v_mfma_f32_16x16x32_bf16 v[16:19], v[104:107], v[128:131], v[16:19]
    v_mfma_f32_16x16x32_bf16 v[20:23], v[108:111], v[128:131], v[20:23]
    v_mfma_f32_16x16x32_bf16 v[24:27], v[112:115], v[128:131], v[24:27]
    v_mfma_f32_16x16x32_bf16 v[28:31], v[116:119], v[128:131], v[28:31]
    v_mfma_f32_16x16x32_bf16 v[32:35], v[120:123], v[128:131], v[32:35]
    v_xor_b32 v15, 192, v77
    ds_read_b128 v[128:131], v15 offset:20480
    ds_read_b64_tr_b16 v[104:105], v76 offset:15360
    ds_read_b64_tr_b16 v[106:107], v76 offset:16640
    ds_read_b64_tr_b16 v[108:109], v76 offset:15392
    ds_read_b64_tr_b16 v[110:111], v76 offset:16672
    ds_read_b64_tr_b16 v[112:113], v76 offset:15424
    ds_read_b64_tr_b16 v[114:115], v76 offset:16704
    ds_read_b64_tr_b16 v[116:117], v76 offset:15456
    ds_read_b64_tr_b16 v[118:119], v76 offset:16736
    ds_read_b64_tr_b16 v[120:121], v76 offset:15488
    ds_read_b64_tr_b16 v[122:123], v76 offset:16768
    s_waitcnt lgkmcnt(11)
    v_mfma_f32_16x16x32_bf16 v[16:19], v[84:87], v[124:127], v[16:19]
    v_mfma_f32_16x16x32_bf16 v[20:23], v[88:91], v[124:127], v[20:23]
    v_mfma_f32_16x16x32_bf16 v[24:27], v[92:95], v[124:127], v[24:27]
    v_mfma_f32_16x16x32_bf16 v[28:31], v[96:99], v[124:127], v[28:31]
    v_mfma_f32_16x16x32_bf16 v[32:35], v[100:103], v[124:127], v[32:35]
    s_waitcnt lgkmcnt(0)
    v_mfma_f32_16x16x32_bf16 v[16:19], v[104:107], v[128:131], v[16:19]
    v_mfma_f32_16x16x32_bf16 v[20:23], v[108:111], v[128:131], v[20:23]
    v_mfma_f32_16x16x32_bf16 v[24:27], v[112:115], v[128:131], v[24:27]
    v_mfma_f32_16x16x32_bf16 v[28:31], v[116:119], v[128:131], v[28:31]
    v_mfma_f32_16x16x32_bf16 v[32:35], v[120:123], v[128:131], v[32:35]
    s_barrier
    v_add_u32 v76, 36864, v6
    v_add_u32 v77, 36864, v8
    ds_read_b128 v[124:127], v77 offset:20480
    ds_read_b64_tr_b16 v[84:85], v76 offset:0
    ds_read_b64_tr_b16 v[86:87], v76 offset:1280
    ds_read_b64_tr_b16 v[88:89], v76 offset:32
    ds_read_b64_tr_b16 v[90:91], v76 offset:1312
    ds_read_b64_tr_b16 v[92:93], v76 offset:64
    ds_read_b64_tr_b16 v[94:95], v76 offset:1344
    ds_read_b64_tr_b16 v[96:97], v76 offset:96
    ds_read_b64_tr_b16 v[98:99], v76 offset:1376
    ds_read_b64_tr_b16 v[100:101], v76 offset:128
    ds_read_b64_tr_b16 v[102:103], v76 offset:1408
    v_xor_b32 v15, 64, v77
    ds_read_b128 v[128:131], v15 offset:20480
    ds_read_b64_tr_b16 v[104:105], v76 offset:5120
    ds_read_b64_tr_b16 v[106:107], v76 offset:6400
    ds_read_b64_tr_b16 v[108:109], v76 offset:5152
    ds_read_b64_tr_b16 v[110:111], v76 offset:6432
    ds_read_b64_tr_b16 v[112:113], v76 offset:5184
    ds_read_b64_tr_b16 v[114:115], v76 offset:6464
    ds_read_b64_tr_b16 v[116:117], v76 offset:5216
    ds_read_b64_tr_b16 v[118:119], v76 offset:6496
    ds_read_b64_tr_b16 v[120:121], v76 offset:5248
    ds_read_b64_tr_b16 v[122:123], v76 offset:6528
    s_waitcnt lgkmcnt(11)
    v_mfma_f32_16x16x32_bf16 v[16:19], v[84:87], v[124:127], v[16:19]
    v_mfma_f32_16x16x32_bf16 v[20:23], v[88:91], v[124:127], v[20:23]
    v_mfma_f32_16x16x32_bf16 v[24:27], v[92:95], v[124:127], v[24:27]
    v_mfma_f32_16x16x32_bf16 v[28:31], v[96:99], v[124:127], v[28:31]
    v_mfma_f32_16x16x32_bf16 v[32:35], v[100:103], v[124:127], v[32:35]
    v_xor_b32 v15, 128, v77
    ds_read_b128 v[124:127], v15 offset:20480
    ds_read_b64_tr_b16 v[84:85], v76 offset:10240
    ds_read_b64_tr_b16 v[86:87], v76 offset:11520
    ds_read_b64_tr_b16 v[88:89], v76 offset:10272
    ds_read_b64_tr_b16 v[90:91], v76 offset:11552
    ds_read_b64_tr_b16 v[92:93], v76 offset:10304
    ds_read_b64_tr_b16 v[94:95], v76 offset:11584
    ds_read_b64_tr_b16 v[96:97], v76 offset:10336
    ds_read_b64_tr_b16 v[98:99], v76 offset:11616
    ds_read_b64_tr_b16 v[100:101], v76 offset:10368
    ds_read_b64_tr_b16 v[102:103], v76 offset:11648
    s_waitcnt lgkmcnt(11)
    v_mfma_f32_16x16x32_bf16 v[16:19], v[104:107], v[128:131], v[16:19]
    v_mfma_f32_16x16x32_bf16 v[20:23], v[108:111], v[128:131], v[20:23]
    v_mfma_f32_16x16x32_bf16 v[24:27], v[112:115], v[128:131], v[24:27]
    v_mfma_f32_16x16x32_bf16 v[28:31], v[116:119], v[128:131], v[28:31]
    v_mfma_f32_16x16x32_bf16 v[32:35], v[120:123], v[128:131], v[32:35]
    v_xor_b32 v15, 192, v77
    ds_read_b128 v[128:131], v15 offset:20480
    ds_read_b64_tr_b16 v[104:105], v76 offset:15360
    ds_read_b64_tr_b16 v[106:107], v76 offset:16640
    ds_read_b64_tr_b16 v[108:109], v76 offset:15392
    ds_read_b64_tr_b16 v[110:111], v76 offset:16672
    ds_read_b64_tr_b16 v[112:113], v76 offset:15424
    ds_read_b64_tr_b16 v[114:115], v76 offset:16704
    ds_read_b64_tr_b16 v[116:117], v76 offset:15456
    ds_read_b64_tr_b16 v[118:119], v76 offset:16736
    ds_read_b64_tr_b16 v[120:121], v76 offset:15488
    ds_read_b64_tr_b16 v[122:123], v76 offset:16768
    s_waitcnt lgkmcnt(11)
    v_mfma_f32_16x16x32_bf16 v[16:19], v[84:87], v[124:127], v[16:19]
    v_mfma_f32_16x16x32_bf16 v[20:23], v[88:91], v[124:127], v[20:23]
    v_mfma_f32_16x16x32_bf16 v[24:27], v[92:95], v[124:127], v[24:27]
    v_mfma_f32_16x16x32_bf16 v[28:31], v[96:99], v[124:127], v[28:31]
    v_mfma_f32_16x16x32_bf16 v[32:35], v[100:103], v[124:127], v[32:35]
    s_waitcnt lgkmcnt(0)
    v_mfma_f32_16x16x32_bf16 v[16:19], v[104:107], v[128:131], v[16:19]
    v_mfma_f32_16x16x32_bf16 v[20:23], v[108:111], v[128:131], v[20:23]
    v_mfma_f32_16x16x32_bf16 v[24:27], v[112:115], v[128:131], v[24:27]
    v_mfma_f32_16x16x32_bf16 v[28:31], v[116:119], v[128:131], v[28:31]
    v_mfma_f32_16x16x32_bf16 v[32:35], v[120:123], v[128:131], v[32:35]
    s_barrier
    v_add_u32 v76, 73728, v6
    v_add_u32 v77, 73728, v8
    ds_read_b128 v[124:127], v77 offset:20480
    ds_read_b64_tr_b16 v[84:85], v76 offset:0
    ds_read_b64_tr_b16 v[86:87], v76 offset:1280
    ds_read_b64_tr_b16 v[88:89], v76 offset:32
    ds_read_b64_tr_b16 v[90:91], v76 offset:1312
    ds_read_b64_tr_b16 v[92:93], v76 offset:64
    ds_read_b64_tr_b16 v[94:95], v76 offset:1344
    ds_read_b64_tr_b16 v[96:97], v76 offset:96
    ds_read_b64_tr_b16 v[98:99], v76 offset:1376
    ds_read_b64_tr_b16 v[100:101], v76 offset:128
    ds_read_b64_tr_b16 v[102:103], v76 offset:1408
    v_xor_b32 v15, 64, v77
    ds_read_b128 v[128:131], v15 offset:20480
    ds_read_b64_tr_b16 v[104:105], v76 offset:5120
    ds_read_b64_tr_b16 v[106:107], v76 offset:6400
    ds_read_b64_tr_b16 v[108:109], v76 offset:5152
    ds_read_b64_tr_b16 v[110:111], v76 offset:6432
    ds_read_b64_tr_b16 v[112:113], v76 offset:5184
    ds_read_b64_tr_b16 v[114:115], v76 offset:6464
    ds_read_b64_tr_b16 v[116:117], v76 offset:5216
    ds_read_b64_tr_b16 v[118:119], v76 offset:6496
    ds_read_b64_tr_b16 v[120:121], v76 offset:5248
    ds_read_b64_tr_b16 v[122:123], v76 offset:6528
    s_waitcnt lgkmcnt(11)
    v_mfma_f32_16x16x32_bf16 v[16:19], v[84:87], v[124:127], v[16:19]
    v_mfma_f32_16x16x32_bf16 v[20:23], v[88:91], v[124:127], v[20:23]
    v_mfma_f32_16x16x32_bf16 v[24:27], v[92:95], v[124:127], v[24:27]
    v_mfma_f32_16x16x32_bf16 v[28:31], v[96:99], v[124:127], v[28:31]
    v_mfma_f32_16x16x32_bf16 v[32:35], v[100:103], v[124:127], v[32:35]
    v_xor_b32 v15, 128, v77
    ds_read_b128 v[124:127], v15 offset:20480
    ds_read_b64_tr_b16 v[84:85], v76 offset:10240
    ds_read_b64_tr_b16 v[86:87], v76 offset:11520
    ds_read_b64_tr_b16 v[88:89], v76 offset:10272
    ds_read_b64_tr_b16 v[90:91], v76 offset:11552
    ds_read_b64_tr_b16 v[92:93], v76 offset:10304
    ds_read_b64_tr_b16 v[94:95], v76 offset:11584
    ds_read_b64_tr_b16 v[96:97], v76 offset:10336
    ds_read_b64_tr_b16 v[98:99], v76 offset:11616
    ds_read_b64_tr_b16 v[100:101], v76 offset:10368
    ds_read_b64_tr_b16 v[102:103], v76 offset:11648
    s_waitcnt lgkmcnt(11)
    v_mfma_f32_16x16x32_bf16 v[16:19], v[104:107], v[128:131], v[16:19]
    v_mfma_f32_16x16x32_bf16 v[20:23], v[108:111], v[128:131], v[20:23]
    v_mfma_f32_16x16x32_bf16 v[24:27], v[112:115], v[128:131], v[24:27]
    v_mfma_f32_16x16x32_bf16 v[28:31], v[116:119], v[128:131], v[28:31]
    v_mfma_f32_16x16x32_bf16 v[32:35], v[120:123], v[128:131], v[32:35]
    v_xor_b32 v15, 192, v77
    ds_read_b128 v[128:131], v15 offset:20480
    ds_read_b64_tr_b16 v[104:105], v76 offset:15360
    ds_read_b64_tr_b16 v[106:107], v76 offset:16640
    ds_read_b64_tr_b16 v[108:109], v76 offset:15392
    ds_read_b64_tr_b16 v[110:111], v76 offset:16672
    ds_read_b64_tr_b16 v[112:113], v76 offset:15424
    ds_read_b64_tr_b16 v[114:115], v76 offset:16704
    ds_read_b64_tr_b16 v[116:117], v76 offset:15456
    ds_read_b64_tr_b16 v[118:119], v76 offset:16736
    ds_read_b64_tr_b16 v[120:121], v76 offset:15488
    ds_read_b64_tr_b16 v[122:123], v76 offset:16768
    s_waitcnt lgkmcnt(11)
    v_mfma_f32_16x16x32_bf16 v[16:19], v[84:87], v[124:127], v[16:19]
    v_mfma_f32_16x16x32_bf16 v[20:23], v[88:91], v[124:127], v[20:23]
    v_mfma_f32_16x16x32_bf16 v[24:27], v[92:95], v[124:127], v[24:27]
    v_mfma_f32_16x16x32_bf16 v[28:31], v[96:99], v[124:127], v[28:31]
    v_mfma_f32_16x16x32_bf16 v[32:35], v[100:103], v[124:127], v[32:35]
    s_waitcnt lgkmcnt(0)
    v_mfma_f32_16x16x32_bf16 v[16:19], v[104:107], v[128:131], v[16:19]
    v_mfma_f32_16x16x32_bf16 v[20:23], v[108:111], v[128:131], v[20:23]
    v_mfma_f32_16x16x32_bf16 v[24:27], v[112:115], v[128:131], v[24:27]
    v_mfma_f32_16x16x32_bf16 v[28:31], v[116:119], v[128:131], v[28:31]
    v_mfma_f32_16x16x32_bf16 v[32:35], v[120:123], v[128:131], v[32:35]
    s_barrier
    v_add_u32 v76, 110592, v6
    v_add_u32 v77, 110592, v8
    ds_read_b128 v[124:127], v77 offset:20480
    ds_read_b64_tr_b16 v[84:85], v76 offset:0
    ds_read_b64_tr_b16 v[86:87], v76 offset:1280
    ds_read_b64_tr_b16 v[88:89], v76 offset:32
    ds_read_b64_tr_b16 v[90:91], v76 offset:1312
    ds_read_b64_tr_b16 v[92:93], v76 offset:64
    ds_read_b64_tr_b16 v[94:95], v76 offset:1344
    ds_read_b64_tr_b16 v[96:97], v76 offset:96
    ds_read_b64_tr_b16 v[98:99], v76 offset:1376
    ds_read_b64_tr_b16 v[100:101], v76 offset:128
    ds_read_b64_tr_b16 v[102:103], v76 offset:1408
    v_xor_b32 v15, 64, v77
    ds_read_b128 v[128:131], v15 offset:20480
    ds_read_b64_tr_b16 v[104:105], v76 offset:5120
    ds_read_b64_tr_b16 v[106:107], v76 offset:6400
    ds_read_b64_tr_b16 v[108:109], v76 offset:5152
    ds_read_b64_tr_b16 v[110:111], v76 offset:6432
    ds_read_b64_tr_b16 v[112:113], v76 offset:5184
    ds_read_b64_tr_b16 v[114:115], v76 offset:6464
    ds_read_b64_tr_b16 v[116:117], v76 offset:5216
    ds_read_b64_tr_b16 v[118:119], v76 offset:6496
    ds_read_b64_tr_b16 v[120:121], v76 offset:5248
    ds_read_b64_tr_b16 v[122:123], v76 offset:6528
    s_waitcnt lgkmcnt(11)
    v_mfma_f32_16x16x32_bf16 v[16:19], v[84:87], v[124:127], v[16:19]
    v_mfma_f32_16x16x32_bf16 v[20:23], v[88:91], v[124:127], v[20:23]
    v_mfma_f32_16x16x32_bf16 v[24:27], v[92:95], v[124:127], v[24:27]
    v_mfma_f32_16x16x32_bf16 v[28:31], v[96:99], v[124:127], v[28:31]
    v_mfma_f32_16x16x32_bf16 v[32:35], v[100:103], v[124:127], v[32:35]
    v_xor_b32 v15, 128, v77
    ds_read_b128 v[124:127], v15 offset:20480
    ds_read_b64_tr_b16 v[84:85], v76 offset:10240
    ds_read_b64_tr_b16 v[86:87], v76 offset:11520
    ds_read_b64_tr_b16 v[88:89], v76 offset:10272
    ds_read_b64_tr_b16 v[90:91], v76 offset:11552
    ds_read_b64_tr_b16 v[92:93], v76 offset:10304
    ds_read_b64_tr_b16 v[94:95], v76 offset:11584
    ds_read_b64_tr_b16 v[96:97], v76 offset:10336
    ds_read_b64_tr_b16 v[98:99], v76 offset:11616
    ds_read_b64_tr_b16 v[100:101], v76 offset:10368
    ds_read_b64_tr_b16 v[102:103], v76 offset:11648
    s_waitcnt lgkmcnt(11)
    v_mfma_f32_16x16x32_bf16 v[16:19], v[104:107], v[128:131], v[16:19]
    v_mfma_f32_16x16x32_bf16 v[20:23], v[108:111], v[128:131], v[20:23]
    v_mfma_f32_16x16x32_bf16 v[24:27], v[112:115], v[128:131], v[24:27]
    v_mfma_f32_16x16x32_bf16 v[28:31], v[116:119], v[128:131], v[28:31]
    v_mfma_f32_16x16x32_bf16 v[32:35], v[120:123], v[128:131], v[32:35]
    v_xor_b32 v15, 192, v77
    ds_read_b128 v[128:131], v15 offset:20480
    ds_read_b64_tr_b16 v[104:105], v76 offset:15360
    ds_read_b64_tr_b16 v[106:107], v76 offset:16640
    ds_read_b64_tr_b16 v[108:109], v76 offset:15392
    ds_read_b64_tr_b16 v[110:111], v76 offset:16672
    ds_read_b64_tr_b16 v[112:113], v76 offset:15424
    ds_read_b64_tr_b16 v[114:115], v76 offset:16704
    ds_read_b64_tr_b16 v[116:117], v76 offset:15456
    ds_read_b64_tr_b16 v[118:119], v76 offset:16736
    ds_read_b64_tr_b16 v[120:121], v76 offset:15488
    ds_read_b64_tr_b16 v[122:123], v76 offset:16768
    s_waitcnt lgkmcnt(11)
    v_mfma_f32_16x16x32_bf16 v[16:19], v[84:87], v[124:127], v[16:19]
    v_mfma_f32_16x16x32_bf16 v[20:23], v[88:91], v[124:127], v[20:23]
    v_mfma_f32_16x16x32_bf16 v[24:27], v[92:95], v[124:127], v[24:27]
    v_mfma_f32_16x16x32_bf16 v[28:31], v[96:99], v[124:127], v[28:31]
    v_mfma_f32_16x16x32_bf16 v[32:35], v[100:103], v[124:127], v[32:35]
    s_waitcnt lgkmcnt(0)
    v_mfma_f32_16x16x32_bf16 v[16:19], v[104:107], v[128:131], v[16:19]
    v_mfma_f32_16x16x32_bf16 v[20:23], v[108:111], v[128:131], v[20:23]
    v_mfma_f32_16x16x32_bf16 v[24:27], v[112:115], v[128:131], v[24:27]
    v_mfma_f32_16x16x32_bf16 v[28:31], v[116:119], v[128:131], v[28:31]
    v_mfma_f32_16x16x32_bf16 v[32:35], v[120:123], v[128:131], v[32:35]
    s_barrier
    v_add_u32 v76, 0, v6
    v_add_u32 v77, 0, v8
    ds_read_b128 v[124:127], v77 offset:20480
    ds_read_b64_tr_b16 v[84:85], v76 offset:0
    ds_read_b64_tr_b16 v[86:87], v76 offset:1280
    ds_read_b64_tr_b16 v[88:89], v76 offset:32
    ds_read_b64_tr_b16 v[90:91], v76 offset:1312
    ds_read_b64_tr_b16 v[92:93], v76 offset:64
    ds_read_b64_tr_b16 v[94:95], v76 offset:1344
    ds_read_b64_tr_b16 v[96:97], v76 offset:96
    ds_read_b64_tr_b16 v[98:99], v76 offset:1376
    ds_read_b64_tr_b16 v[100:101], v76 offset:128
    ds_read_b64_tr_b16 v[102:103], v76 offset:1408
    v_xor_b32 v15, 64, v77
    ds_read_b128 v[128:131], v15 offset:20480
    ds_read_b64_tr_b16 v[104:105], v76 offset:5120
    ds_read_b64_tr_b16 v[106:107], v76 offset:6400
    ds_read_b64_tr_b16 v[108:109], v76 offset:5152
    ds_read_b64_tr_b16 v[110:111], v76 offset:6432
    ds_read_b64_tr_b16 v[112:113], v76 offset:5184
    ds_read_b64_tr_b16 v[114:115], v76 offset:6464
    ds_read_b64_tr_b16 v[116:117], v76 offset:5216
    ds_read_b64_tr_b16 v[118:119], v76 offset:6496
    ds_read_b64_tr_b16 v[120:121], v76 offset:5248
    ds_read_b64_tr_b16 v[122:123], v76 offset:6528
    s_waitcnt lgkmcnt(11)
    v_mfma_f32_16x16x32_bf16 v[16:19], v[84:87], v[124:127], v[16:19]
    v_mfma_f32_16x16x32_bf16 v[20:23], v[88:91], v[124:127], v[20:23]
    v_mfma_f32_16x16x32_bf16 v[24:27], v[92:95], v[124:127], v[24:27]
    v_mfma_f32_16x16x32_bf16 v[28:31], v[96:99], v[124:127], v[28:31]
    v_mfma_f32_16x16x32_bf16 v[32:35], v[100:103], v[124:127], v[32:35]
    v_xor_b32 v15, 128, v77
    ds_read_b128 v[124:127], v15 offset:20480
    ds_read_b64_tr_b16 v[84:85], v76 offset:10240
    ds_read_b64_tr_b16 v[86:87], v76 offset:11520
    ds_read_b64_tr_b16 v[88:89], v76 offset:10272
    ds_read_b64_tr_b16 v[90:91], v76 offset:11552
    ds_read_b64_tr_b16 v[92:93], v76 offset:10304
    ds_read_b64_tr_b16 v[94:95], v76 offset:11584
    ds_read_b64_tr_b16 v[96:97], v76 offset:10336
    ds_read_b64_tr_b16 v[98:99], v76 offset:11616
    ds_read_b64_tr_b16 v[100:101], v76 offset:10368
    ds_read_b64_tr_b16 v[102:103], v76 offset:11648
    s_waitcnt lgkmcnt(11)
    v_mfma_f32_16x16x32_bf16 v[16:19], v[104:107], v[128:131], v[16:19]
    v_mfma_f32_16x16x32_bf16 v[20:23], v[108:111], v[128:131], v[20:23]
    v_mfma_f32_16x16x32_bf16 v[24:27], v[112:115], v[128:131], v[24:27]
    v_mfma_f32_16x16x32_bf16 v[28:31], v[116:119], v[128:131], v[28:31]
    v_mfma_f32_16x16x32_bf16 v[32:35], v[120:123], v[128:131], v[32:35]
    v_xor_b32 v15, 192, v77
    ds_read_b128 v[128:131], v15 offset:20480
    ds_read_b64_tr_b16 v[104:105], v76 offset:15360
    ds_read_b64_tr_b16 v[106:107], v76 offset:16640
    ds_read_b64_tr_b16 v[108:109], v76 offset:15392
    ds_read_b64_tr_b16 v[110:111], v76 offset:16672
    ds_read_b64_tr_b16 v[112:113], v76 offset:15424
    ds_read_b64_tr_b16 v[114:115], v76 offset:16704
    ds_read_b64_tr_b16 v[116:117], v76 offset:15456
    ds_read_b64_tr_b16 v[118:119], v76 offset:16736
    ds_read_b64_tr_b16 v[120:121], v76 offset:15488
    ds_read_b64_tr_b16 v[122:123], v76 offset:16768
    s_waitcnt lgkmcnt(11)
    v_mfma_f32_16x16x32_bf16 v[16:19], v[84:87], v[124:127], v[16:19]
    v_mfma_f32_16x16x32_bf16 v[20:23], v[88:91], v[124:127], v[20:23]
    v_mfma_f32_16x16x32_bf16 v[24:27], v[92:95], v[124:127], v[24:27]
    v_mfma_f32_16x16x32_bf16 v[28:31], v[96:99], v[124:127], v[28:31]
    v_mfma_f32_16x16x32_bf16 v[32:35], v[100:103], v[124:127], v[32:35]
    s_waitcnt lgkmcnt(0)
    v_mfma_f32_16x16x32_bf16 v[16:19], v[104:107], v[128:131], v[16:19]
    v_mfma_f32_16x16x32_bf16 v[20:23], v[108:111], v[128:131], v[20:23]
    v_mfma_f32_16x16x32_bf16 v[24:27], v[112:115], v[128:131], v[24:27]
    v_mfma_f32_16x16x32_bf16 v[28:31], v[116:119], v[128:131], v[28:31]
    v_mfma_f32_16x16x32_bf16 v[32:35], v[120:123], v[128:131], v[32:35]
    s_waitcnt vmcnt(0)
    v_lshlrev_b32 v81, 16, v81
    v_sub_f32 v83, 1.0, v80
    v_cvt_pk_bf16_f32 v83, v83, v83
    v_and_b32 v83, 0xffff0000, v83
    s_nop 7
    v_cvt_pk_bf16_f32 v56, v16, v17
    v_cvt_pk_bf16_f32 v57, v36, v37
    v_lshlrev_b32 v58, 16, v56
    v_and_b32 v56, 0xffff0000, v56
    v_lshlrev_b32 v59, 16, v57
    v_and_b32 v57, 0xffff0000, v57
    v_add_f32 v59, v59, v81
    v_add_f32 v57, v57, v81
    v_cvt_pk_bf16_f32 v57, v59, v57
    v_lshlrev_b32 v59, 16, v57
    v_and_b32 v57, 0xffff0000, v57
    v_mul_f32 v58, v58, v80
    v_mul_f32 v56, v56, v80
    v_mul_f32 v59, v59, v83
    v_mul_f32 v57, v57, v83
    v_cvt_pk_bf16_f32 v56, v58, v56
    v_cvt_pk_bf16_f32 v57, v59, v57
    v_lshlrev_b32 v58, 16, v56
    v_and_b32 v56, 0xffff0000, v56
    v_lshlrev_b32 v59, 16, v57
    v_and_b32 v57, 0xffff0000, v57
    v_add_f32 v58, v58, v59
    v_add_f32 v56, v56, v57
    v_cvt_pk_bf16_f32 v84, v58, v56
    v_cvt_pk_bf16_f32 v56, v18, v19
    v_cvt_pk_bf16_f32 v57, v38, v39
    v_lshlrev_b32 v58, 16, v56
    v_and_b32 v56, 0xffff0000, v56
    v_lshlrev_b32 v59, 16, v57
    v_and_b32 v57, 0xffff0000, v57
    v_add_f32 v59, v59, v81
    v_add_f32 v57, v57, v81
    v_cvt_pk_bf16_f32 v57, v59, v57
    v_lshlrev_b32 v59, 16, v57
    v_and_b32 v57, 0xffff0000, v57
    v_mul_f32 v58, v58, v80
    v_mul_f32 v56, v56, v80
    v_mul_f32 v59, v59, v83
    v_mul_f32 v57, v57, v83
    v_cvt_pk_bf16_f32 v56, v58, v56
    v_cvt_pk_bf16_f32 v57, v59, v57
    v_lshlrev_b32 v58, 16, v56
    v_and_b32 v56, 0xffff0000, v56
    v_lshlrev_b32 v59, 16, v57
    v_and_b32 v57, 0xffff0000, v57
    v_add_f32 v58, v58, v59
    v_add_f32 v56, v56, v57
    v_cvt_pk_bf16_f32 v85, v58, v56
    v_cvt_pk_bf16_f32 v56, v20, v21
    v_cvt_pk_bf16_f32 v57, v40, v41
    v_lshlrev_b32 v58, 16, v56
    v_and_b32 v56, 0xffff0000, v56
    v_lshlrev_b32 v59, 16, v57
    v_and_b32 v57, 0xffff0000, v57
    v_add_f32 v59, v59, v81
    v_add_f32 v57, v57, v81
    v_cvt_pk_bf16_f32 v57, v59, v57
    v_lshlrev_b32 v59, 16, v57
    v_and_b32 v57, 0xffff0000, v57
    v_mul_f32 v58, v58, v80
    v_mul_f32 v56, v56, v80
    v_mul_f32 v59, v59, v83
    v_mul_f32 v57, v57, v83
    v_cvt_pk_bf16_f32 v56, v58, v56
    v_cvt_pk_bf16_f32 v57, v59, v57
    v_lshlrev_b32 v58, 16, v56
    v_and_b32 v56, 0xffff0000, v56
    v_lshlrev_b32 v59, 16, v57
    v_and_b32 v57, 0xffff0000, v57
    v_add_f32 v58, v58, v59
    v_add_f32 v56, v56, v57
    v_cvt_pk_bf16_f32 v86, v58, v56
    v_cvt_pk_bf16_f32 v56, v22, v23
    v_cvt_pk_bf16_f32 v57, v42, v43
    v_lshlrev_b32 v58, 16, v56
    v_and_b32 v56, 0xffff0000, v56
    v_lshlrev_b32 v59, 16, v57
    v_and_b32 v57, 0xffff0000, v57
    v_add_f32 v59, v59, v81
    v_add_f32 v57, v57, v81
    v_cvt_pk_bf16_f32 v57, v59, v57
    v_lshlrev_b32 v59, 16, v57
    v_and_b32 v57, 0xffff0000, v57
    v_mul_f32 v58, v58, v80
    v_mul_f32 v56, v56, v80
    v_mul_f32 v59, v59, v83
    v_mul_f32 v57, v57, v83
    v_cvt_pk_bf16_f32 v56, v58, v56
    v_cvt_pk_bf16_f32 v57, v59, v57
    v_lshlrev_b32 v58, 16, v56
    v_and_b32 v56, 0xffff0000, v56
    v_lshlrev_b32 v59, 16, v57
    v_and_b32 v57, 0xffff0000, v57
    v_add_f32 v58, v58, v59
    v_add_f32 v56, v56, v57
    v_cvt_pk_bf16_f32 v87, v58, v56
    v_cvt_pk_bf16_f32 v56, v24, v25
    v_cvt_pk_bf16_f32 v57, v44, v45
    v_lshlrev_b32 v58, 16, v56
    v_and_b32 v56, 0xffff0000, v56
    v_lshlrev_b32 v59, 16, v57
    v_and_b32 v57, 0xffff0000, v57
    v_add_f32 v59, v59, v81
    v_add_f32 v57, v57, v81
    v_cvt_pk_bf16_f32 v57, v59, v57
    v_lshlrev_b32 v59, 16, v57
    v_and_b32 v57, 0xffff0000, v57
    v_mul_f32 v58, v58, v80
    v_mul_f32 v56, v56, v80
    v_mul_f32 v59, v59, v83
    v_mul_f32 v57, v57, v83
    v_cvt_pk_bf16_f32 v56, v58, v56
    v_cvt_pk_bf16_f32 v57, v59, v57
    v_lshlrev_b32 v58, 16, v56
    v_and_b32 v56, 0xffff0000, v56
    v_lshlrev_b32 v59, 16, v57
    v_and_b32 v57, 0xffff0000, v57
    v_add_f32 v58, v58, v59
    v_add_f32 v56, v56, v57
    v_cvt_pk_bf16_f32 v88, v58, v56
    v_cvt_pk_bf16_f32 v56, v26, v27
    v_cvt_pk_bf16_f32 v57, v46, v47
    v_lshlrev_b32 v58, 16, v56
    v_and_b32 v56, 0xffff0000, v56
    v_lshlrev_b32 v59, 16, v57
    v_and_b32 v57, 0xffff0000, v57
    v_add_f32 v59, v59, v81
    v_add_f32 v57, v57, v81
    v_cvt_pk_bf16_f32 v57, v59, v57
    v_lshlrev_b32 v59, 16, v57
    v_and_b32 v57, 0xffff0000, v57
    v_mul_f32 v58, v58, v80
    v_mul_f32 v56, v56, v80
    v_mul_f32 v59, v59, v83
    v_mul_f32 v57, v57, v83
    v_cvt_pk_bf16_f32 v56, v58, v56
    v_cvt_pk_bf16_f32 v57, v59, v57
    v_lshlrev_b32 v58, 16, v56
    v_and_b32 v56, 0xffff0000, v56
    v_lshlrev_b32 v59, 16, v57
    v_and_b32 v57, 0xffff0000, v57
    v_add_f32 v58, v58, v59
    v_add_f32 v56, v56, v57
    v_cvt_pk_bf16_f32 v89, v58, v56
    v_cvt_pk_bf16_f32 v56, v28, v29
    v_cvt_pk_bf16_f32 v57, v48, v49
    v_lshlrev_b32 v58, 16, v56
    v_and_b32 v56, 0xffff0000, v56
    v_lshlrev_b32 v59, 16, v57
    v_and_b32 v57, 0xffff0000, v57
    v_add_f32 v59, v59, v81
    v_add_f32 v57, v57, v81
    v_cvt_pk_bf16_f32 v57, v59, v57
    v_lshlrev_b32 v59, 16, v57
    v_and_b32 v57, 0xffff0000, v57
    v_mul_f32 v58, v58, v80
    v_mul_f32 v56, v56, v80
    v_mul_f32 v59, v59, v83
    v_mul_f32 v57, v57, v83
    v_cvt_pk_bf16_f32 v56, v58, v56
    v_cvt_pk_bf16_f32 v57, v59, v57
    v_lshlrev_b32 v58, 16, v56
    v_and_b32 v56, 0xffff0000, v56
    v_lshlrev_b32 v59, 16, v57
    v_and_b32 v57, 0xffff0000, v57
    v_add_f32 v58, v58, v59
    v_add_f32 v56, v56, v57
    v_cvt_pk_bf16_f32 v90, v58, v56
    v_cvt_pk_bf16_f32 v56, v30, v31
    v_cvt_pk_bf16_f32 v57, v50, v51
    v_lshlrev_b32 v58, 16, v56
    v_and_b32 v56, 0xffff0000, v56
    v_lshlrev_b32 v59, 16, v57
    v_and_b32 v57, 0xffff0000, v57
    v_add_f32 v59, v59, v81
    v_add_f32 v57, v57, v81
    v_cvt_pk_bf16_f32 v57, v59, v57
    v_lshlrev_b32 v59, 16, v57
    v_and_b32 v57, 0xffff0000, v57
    v_mul_f32 v58, v58, v80
    v_mul_f32 v56, v56, v80
    v_mul_f32 v59, v59, v83
    v_mul_f32 v57, v57, v83
    v_cvt_pk_bf16_f32 v56, v58, v56
    v_cvt_pk_bf16_f32 v57, v59, v57
    v_lshlrev_b32 v58, 16, v56
    v_and_b32 v56, 0xffff0000, v56
    v_lshlrev_b32 v59, 16, v57
    v_and_b32 v57, 0xffff0000, v57
    v_add_f32 v58, v58, v59
    v_add_f32 v56, v56, v57
    v_cvt_pk_bf16_f32 v91, v58, v56
    v_cvt_pk_bf16_f32 v56, v32, v33
    v_cvt_pk_bf16_f32 v57, v52, v53
    v_lshlrev_b32 v58, 16, v56
    v_and_b32 v56, 0xffff0000, v56
    v_lshlrev_b32 v59, 16, v57
    v_and_b32 v57, 0xffff0000, v57
    v_add_f32 v59, v59, v81
    v_add_f32 v57, v57, v81
    v_cvt_pk_bf16_f32 v57, v59, v57
    v_lshlrev_b32 v59, 16, v57
    v_and_b32 v57, 0xffff0000, v57
    v_mul_f32 v58, v58, v80
    v_mul_f32 v56, v56, v80
    v_mul_f32 v59, v59, v83
    v_mul_f32 v57, v57, v83
    v_cvt_pk_bf16_f32 v56, v58, v56
    v_cvt_pk_bf16_f32 v57, v59, v57
    v_lshlrev_b32 v58, 16, v56
    v_and_b32 v56, 0xffff0000, v56
    v_lshlrev_b32 v59, 16, v57
    v_and_b32 v57, 0xffff0000, v57
    v_add_f32 v58, v58, v59
    v_add_f32 v56, v56, v57
    v_cvt_pk_bf16_f32 v92, v58, v56
    v_cvt_pk_bf16_f32 v56, v34, v35
    v_cvt_pk_bf16_f32 v57, v54, v55
    v_lshlrev_b32 v58, 16, v56
    v_and_b32 v56, 0xffff0000, v56
    v_lshlrev_b32 v59, 16, v57
    v_and_b32 v57, 0xffff0000, v57
    v_add_f32 v59, v59, v81
    v_add_f32 v57, v57, v81
    v_cvt_pk_bf16_f32 v57, v59, v57
    v_lshlrev_b32 v59, 16, v57
    v_and_b32 v57, 0xffff0000, v57
    v_mul_f32 v58, v58, v80
    v_mul_f32 v56, v56, v80
    v_mul_f32 v59, v59, v83
    v_mul_f32 v57, v57, v83
    v_cvt_pk_bf16_f32 v56, v58, v56
    v_cvt_pk_bf16_f32 v57, v59, v57
    v_lshlrev_b32 v58, 16, v56
    v_and_b32 v56, 0xffff0000, v56
    v_lshlrev_b32 v59, 16, v57
    v_and_b32 v57, 0xffff0000, v57
    v_add_f32 v58, v58, v59
    v_add_f32 v56, v56, v57
    v_cvt_pk_bf16_f32 v93, v58, v56
    buffer_store_dwordx2 v[84:85], v82, s[52:55], 0 offen offset:0
    buffer_store_dwordx2 v[86:87], v82, s[52:55], 0 offen offset:32
    buffer_store_dwordx2 v[88:89], v82, s[52:55], 0 offen offset:64
    buffer_store_dwordx2 v[90:91], v82, s[52:55], 0 offen offset:96
    buffer_store_dwordx2 v[92:93], v82, s[52:55], 0 offen offset:128
    s_endpgm
K3_LD:
    s_sub_u32 s3, s3, 4
    v_add_u32 v10, 0, v2
    v_mul_u32_u24 v11, 0x199a, v10
    v_lshrrev_b32 v11, 16, v11
    v_mul_u32_u24 v12, 10, v11
    v_sub_u32 v12, v10, v12
    v_and_b32 v13, 0x13, v11
    v_and_b32 v14, 4, v11
    v_lshlrev_b32 v14, 1, v14
    v_or_b32 v13, v13, v14
    v_and_b32 v14, 8, v11
    v_lshrrev_b32 v14, 1, v14
    v_or_b32 v13, v13, v14
    v_mul_lo_u32 v13, v13, s30
    v_lshlrev_b32 v12, 4, v12
    v_add_u32 v60, v13, v12
    v_add_u32 v10, 64, v2
    v_mul_u32_u24 v11, 0x199a, v10
    v_lshrrev_b32 v11, 16, v11
    v_mul_u32_u24 v12, 10, v11
    v_sub_u32 v12, v10, v12
    v_and_b32 v13, 0x13, v11
    v_and_b32 v14, 4, v11
    v_lshlrev_b32 v14, 1, v14
    v_or_b32 v13, v13, v14
    v_and_b32 v14, 8, v11
    v_lshrrev_b32 v14, 1, v14
    v_or_b32 v13, v13, v14
    v_mul_lo_u32 v13, v13, s30
    v_lshlrev_b32 v12, 4, v12
    v_add_u32 v61, v13, v12
    v_add_u32 v10, 128, v2
    v_mul_u32_u24 v11, 0x199a, v10
    v_lshrrev_b32 v11, 16, v11
    v_mul_u32_u24 v12, 10, v11
    v_sub_u32 v12, v10, v12
    v_and_b32 v13, 0x13, v11
    v_and_b32 v14, 4, v11
    v_lshlrev_b32 v14, 1, v14
    v_or_b32 v13, v13, v14
    v_and_b32 v14, 8, v11
    v_lshrrev_b32 v14, 1, v14
    v_or_b32 v13, v13, v14
    v_mul_lo_u32 v13, v13, s30
    v_lshlrev_b32 v12, 4, v12
    v_add_u32 v62, v13, v12
    v_add_u32 v10, 192, v2
    v_mul_u32_u24 v11, 0x199a, v10
    v_lshrrev_b32 v11, 16, v11
    v_mul_u32_u24 v12, 10, v11
    v_sub_u32 v12, v10, v12
    v_and_b32 v13, 0x13, v11
    v_and_b32 v14, 4, v11
    v_lshlrev_b32 v14, 1, v14
    v_or_b32 v13, v13, v14
    v_and_b32 v14, 8, v11
    v_lshrrev_b32 v14, 1, v14
    v_or_b32 v13, v13, v14
    v_mul_lo_u32 v13, v13, s30
    v_lshlrev_b32 v12, 4, v12
    v_add_u32 v63, v13, v12
    v_add_u32 v10, 256, v2
    v_mul_u32_u24 v11, 0x199a, v10
    v_lshrrev_b32 v11, 16, v11
    v_mul_u32_u24 v12, 10, v11
    v_sub_u32 v12, v10, v12
    v_and_b32 v13, 0x13, v11
    v_and_b32 v14, 4, v11
    v_lshlrev_b32 v14, 1, v14
    v_or_b32 v13, v13, v14
    v_and_b32 v14, 8, v11
    v_lshrrev_b32 v14, 1, v14
    v_or_b32 v13, v13, v14
    v_mul_lo_u32 v13, v13, s30
    v_lshlrev_b32 v12, 4, v12
    v_add_u32 v64, v13, v12
    s_mul_i32 s35, s3, 20
    v_lshrrev_b32 v10, 4, v2
    v_add_u32 v11, 0, v10
    v_mul_lo_u32 v10, v10, s30
    v_and_b32 v70, 15, v2
    v_xor_b32 v70, v70, v11
    v_lshlrev_b32 v70, 4, v70
    v_add_u32 v70, v70, v10
    v_lshrrev_b32 v10, 4, v2
    v_add_u32 v11, 4, v10
    v_mul_lo_u32 v10, v10, s30
    v_and_b32 v71, 15, v2
    v_xor_b32 v71, v71, v11
    v_lshlrev_b32 v71, 4, v71
    v_add_u32 v71, v71, v10
    v_lshrrev_b32 v10, 4, v2
    v_add_u32 v11, 8, v10
    v_mul_lo_u32 v10, v10, s30
    v_and_b32 v72, 15, v2
    v_xor_b32 v72, v72, v11
    v_lshlrev_b32 v72, 4, v72
    v_add_u32 v72, v72, v10
    v_lshrrev_b32 v10, 4, v2
    v_add_u32 v11, 12, v10
    v_mul_lo_u32 v10, v10, s30
    v_and_b32 v73, 15, v2
    v_xor_b32 v73, v73, v11
    v_lshlrev_b32 v73, 4, v73
    v_add_u32 v73, v73, v10
    v_add_u32 v10, 0, v5
    v_add_u32 v11, s35, v10
    v_and_b32 v11, 15, v11
    v_xor_b32 v11, v11, v4
    v_lshlrev_b32 v11, 4, v11
    v_mul_lo_u32 v10, v10, s56
    v_add_u32 v65, v10, v11
    v_add_u32 v10, 4, v5
    v_add_u32 v11, s35, v10
    v_and_b32 v11, 15, v11
    v_xor_b32 v11, v11, v4
    v_lshlrev_b32 v11, 4, v11
    v_mul_lo_u32 v10, v10, s56
    v_add_u32 v66, v10, v11
    v_add_u32 v10, 8, v5
    v_add_u32 v11, s35, v10
    v_and_b32 v11, 15, v11
    v_xor_b32 v11, v11, v4
    v_lshlrev_b32 v11, 4, v11
    v_mul_lo_u32 v10, v10, s56
    v_add_u32 v67, v10, v11
    v_add_u32 v10, 12, v5
    v_add_u32 v11, s35, v10
    v_and_b32 v11, 15, v11
    v_xor_b32 v11, v11, v4
    v_lshlrev_b32 v11, 4, v11
    v_mul_lo_u32 v10, v10, s56
    v_add_u32 v68, v10, v11
    v_add_u32 v10, 16, v5
    v_add_u32 v11, s35, v10
    v_and_b32 v11, 15, v11
    v_xor_b32 v11, v11, v4
    v_lshlrev_b32 v11, 4, v11
    v_mul_lo_u32 v10, v10, s56
    v_add_u32 v69, v10, v11
    v_lshrrev_b32 v10, 3, v2
    v_mul_lo_u32 v10, v10, s57
    v_lshrrev_b32 v11, 4, v2
    v_and_b32 v11, 1, v11
    v_lshlrev_b32 v11, 2, v11
    v_and_b32 v12, 7, v2
    v_xor_b32 v12, v12, v11
    v_xor_b32 v12, 0, v12
    v_lshlrev_b32 v12, 4, v12
    v_add_u32 v74, v12, v10
    v_lshrrev_b32 v10, 3, v2
    v_mul_lo_u32 v10, v10, s57
    v_lshrrev_b32 v11, 4, v2
    v_and_b32 v11, 1, v11
    v_lshlrev_b32 v11, 2, v11
    v_and_b32 v12, 7, v2
    v_xor_b32 v12, v12, v11
    v_xor_b32 v12, 2, v12
    v_lshlrev_b32 v12, 4, v12
    v_add_u32 v75, v12, v10
    s_mul_i32 s58, s3, 40960
    s_mul_i32 s34, s29, 160
    s_add_u32 s58, s58, s34
    s_mul_i32 s59, s29, 80
    s_add_u32 s59, s59, s35
    s_mul_i32 s59, s59, 3072
    s_lshl_b32 s62, s28, 6
    s_lshl_b32 s34, s3, 4
    s_add_u32 s62, s62, s34
    s_mul_i32 s62, s62, 1280
    s_lshl_b32 s63, s3, 17
    s_lshl_b32 s34, s28, 7
    s_add_u32 s63, s63, s34
    s_mul_i32 s64, s3, 5120
    s_lshl_b32 s65, s3, 12
    s_add_u32 m0, s64, 0
    s_add_u32 s34, s59, 0
    buffer_load_dwordx4 v65, s[16:19], s34 offen lds
    s_add_u32 m0, s64, 1024
    s_add_u32 s34, s59, 0
    buffer_load_dwordx4 v66, s[16:19], s34 offen lds
    s_add_u32 m0, s64, 2048
    s_add_u32 s34, s59, 0
    buffer_load_dwordx4 v67, s[16:19], s34 offen lds
    s_add_u32 m0, s64, 3072
    s_add_u32 s34, s59, 0
    buffer_load_dwordx4 v68, s[16:19], s34 offen lds
    s_add_u32 m0, s64, 4096
    s_add_u32 s34, s59, 0
    buffer_load_dwordx4 v69, s[16:19], s34 offen lds
    s_add_u32 m0, s65, 20480
    s_add_u32 s34, s63, 0
    buffer_load_dwordx4 v74, s[40:43], s34 offen lds
    s_add_u32 m0, s65, 21504
    s_add_u32 s34, s63, 32768
    buffer_load_dwordx4 v75, s[40:43], s34 offen lds
    s_add_u32 m0, s65, 22528
    s_add_u32 s34, s63, 65536
    buffer_load_dwordx4 v74, s[40:43], s34 offen lds
    s_add_u32 m0, s65, 23552
    s_add_u32 s34, s63, 98304
    buffer_load_dwordx4 v75, s[40:43], s34 offen lds
    s_add_u32 m0, s64, 36864
    s_add_u32 s34, s59, 256
    buffer_load_dwordx4 v65, s[16:19], s34 offen lds
    s_add_u32 m0, s64, 37888
    s_add_u32 s34, s59, 256
    buffer_load_dwordx4 v66, s[16:19], s34 offen lds
    s_add_u32 m0, s64, 38912
    s_add_u32 s34, s59, 256
    buffer_load_dwordx4 v67, s[16:19], s34 offen lds
    s_add_u32 m0, s64, 39936
    s_add_u32 s34, s59, 256
    buffer_load_dwordx4 v68, s[16:19], s34 offen lds
    s_add_u32 m0, s64, 40960
    s_add_u32 s34, s59, 256
    buffer_load_dwordx4 v69, s[16:19], s34 offen lds
    s_add_u32 m0, s65, 57344
    s_add_u32 s34, s63, 524288
    buffer_load_dwordx4 v74, s[40:43], s34 offen lds
    s_add_u32 m0, s65, 58368
    s_add_u32 s34, s63, 557056
    buffer_load_dwordx4 v75, s[40:43], s34 offen lds
    s_add_u32 m0, s65, 59392
    s_add_u32 s34, s63, 589824
    buffer_load_dwordx4 v74, s[40:43], s34 offen lds
    s_add_u32 m0, s65, 60416
    s_add_u32 s34, s63, 622592
    buffer_load_dwordx4 v75, s[40:43], s34 offen lds
    s_add_u32 m0, s64, 73728
    s_add_u32 s34, s59, 512
    buffer_load_dwordx4 v65, s[16:19], s34 offen lds
    s_add_u32 m0, s64, 74752
    s_add_u32 s34, s59, 512
    buffer_load_dwordx4 v66, s[16:19], s34 offen lds
    s_add_u32 m0, s64, 75776
    s_add_u32 s34, s59, 512
    buffer_load_dwordx4 v67, s[16:19], s34 offen lds
    s_add_u32 m0, s64, 76800
    s_add_u32 s34, s59, 512
    buffer_load_dwordx4 v68, s[16:19], s34 offen lds
    s_add_u32 m0, s64, 77824
    s_add_u32 s34, s59, 512
    buffer_load_dwordx4 v69, s[16:19], s34 offen lds
    s_add_u32 m0, s65, 94208
    s_add_u32 s34, s63, 1048576
    buffer_load_dwordx4 v74, s[40:43], s34 offen lds
    s_add_u32 m0, s65, 95232
    s_add_u32 s34, s63, 1081344
    buffer_load_dwordx4 v75, s[40:43], s34 offen lds
    s_add_u32 m0, s65, 96256
    s_add_u32 s34, s63, 1114112
    buffer_load_dwordx4 v74, s[40:43], s34 offen lds
    s_add_u32 m0, s65, 97280
    s_add_u32 s34, s63, 1146880
    buffer_load_dwordx4 v75, s[40:43], s34 offen lds
    s_waitcnt vmcnt(18)
    s_barrier
    s_add_u32 m0, s64, 110592
    s_add_u32 s34, s59, 768
    buffer_load_dwordx4 v65, s[16:19], s34 offen lds
    s_add_u32 m0, s64, 111616
    s_add_u32 s34, s59, 768
    buffer_load_dwordx4 v66, s[16:19], s34 offen lds
    s_add_u32 m0, s64, 112640
    s_add_u32 s34, s59, 768
    buffer_load_dwordx4 v67, s[16:19], s34 offen lds
    s_add_u32 m0, s64, 113664
    s_add_u32 s34, s59, 768
    buffer_load_dwordx4 v68, s[16:19], s34 offen lds
    s_add_u32 m0, s64, 114688
    s_add_u32 s34, s59, 768
    buffer_load_dwordx4 v69, s[16:19], s34 offen lds
    s_add_u32 m0, s65, 131072
    s_add_u32 s34, s63, 1572864
    buffer_load_dwordx4 v74, s[40:43], s34 offen lds
    s_add_u32 m0, s65, 132096
    s_add_u32 s34, s63, 1605632
    buffer_load_dwordx4 v75, s[40:43], s34 offen lds
    s_add_u32 m0, s65, 133120
    s_add_u32 s34, s63, 1638400
    buffer_load_dwordx4 v74, s[40:43], s34 offen lds
    s_add_u32 m0, s65, 134144
    s_add_u32 s34, s63, 1671168
    buffer_load_dwordx4 v75, s[40:43], s34 offen lds
    s_waitcnt vmcnt(18)
    s_barrier
    s_add_u32 m0, s64, 0
    s_add_u32 s34, s59, 1024
    buffer_load_dwordx4 v65, s[16:19], s34 offen lds
    s_add_u32 m0, s64, 1024
    s_add_u32 s34, s59, 1024
    buffer_load_dwordx4 v66, s[16:19], s34 offen lds
    s_add_u32 m0, s64, 2048
    s_add_u32 s34, s59, 1024
    buffer_load_dwordx4 v67, s[16:19], s34 offen lds
    s_add_u32 m0, s64, 3072
    s_add_u32 s34, s59, 1024
    buffer_load_dwordx4 v68, s[16:19], s34 offen lds
    s_add_u32 m0, s64, 4096
    s_add_u32 s34, s59, 1024
    buffer_load_dwordx4 v69, s[16:19], s34 offen lds
    s_add_u32 m0, s65, 20480
    s_add_u32 s34, s63, 2097152
    buffer_load_dwordx4 v74, s[40:43], s34 offen lds
    s_add_u32 m0, s65, 21504
    s_add_u32 s34, s63, 2129920
    buffer_load_dwordx4 v75, s[40:43], s34 offen lds
    s_add_u32 m0, s65, 22528
    s_add_u32 s34, s63, 2162688
    buffer_load_dwordx4 v74, s[40:43], s34 offen lds
    s_add_u32 m0, s65, 23552
    s_add_u32 s34, s63, 2195456
    buffer_load_dwordx4 v75, s[40:43], s34 offen lds
    s_waitcnt vmcnt(18)
    s_barrier
    s_add_u32 m0, s64, 36864
    s_add_u32 s34, s59, 1280
    buffer_load_dwordx4 v65, s[16:19], s34 offen lds
    s_add_u32 m0, s64, 37888
    s_add_u32 s34, s59, 1280
    buffer_load_dwordx4 v66, s[16:19], s34 offen lds
    s_add_u32 m0, s64, 38912
    s_add_u32 s34, s59, 1280
    buffer_load_dwordx4 v67, s[16:19], s34 offen lds
    s_add_u32 m0, s64, 39936
    s_add_u32 s34, s59, 1280
    buffer_load_dwordx4 v68, s[16:19], s34 offen lds
    s_add_u32 m0, s64, 40960
    s_add_u32 s34, s59, 1280
    buffer_load_dwordx4 v69, s[16:19], s34 offen lds
    s_add_u32 m0, s65, 57344
    s_add_u32 s34, s63, 2621440
    buffer_load_dwordx4 v74, s[40:43], s34 offen lds
    s_add_u32 m0, s65, 58368
    s_add_u32 s34, s63, 2654208
    buffer_load_dwordx4 v75, s[40:43], s34 offen lds
    s_add_u32 m0, s65, 59392
    s_add_u32 s34, s63, 2686976
    buffer_load_dwordx4 v74, s[40:43], s34 offen lds
    s_add_u32 m0, s65, 60416
    s_add_u32 s34, s63, 2719744
    buffer_load_dwordx4 v75, s[40:43], s34 offen lds
    s_waitcnt vmcnt(18)
    s_barrier
    s_add_u32 m0, s64, 73728
    s_add_u32 s34, s59, 1536
    buffer_load_dwordx4 v65, s[16:19], s34 offen lds
    s_add_u32 m0, s64, 74752
    s_add_u32 s34, s59, 1536
    buffer_load_dwordx4 v66, s[16:19], s34 offen lds
    s_add_u32 m0, s64, 75776
    s_add_u32 s34, s59, 1536
    buffer_load_dwordx4 v67, s[16:19], s34 offen lds
    s_add_u32 m0, s64, 76800
    s_add_u32 s34, s59, 1536
    buffer_load_dwordx4 v68, s[16:19], s34 offen lds
    s_add_u32 m0, s64, 77824
    s_add_u32 s34, s59, 1536
    buffer_load_dwordx4 v69, s[16:19], s34 offen lds
    s_add_u32 m0, s65, 94208
    s_add_u32 s34, s63, 3145728
    buffer_load_dwordx4 v74, s[40:43], s34 offen lds
    s_add_u32 m0, s65, 95232
    s_add_u32 s34, s63, 3178496
    buffer_load_dwordx4 v75, s[40:43], s34 offen lds
    s_add_u32 m0, s65, 96256
    s_add_u32 s34, s63, 3211264
    buffer_load_dwordx4 v74, s[40:43], s34 offen lds
    s_add_u32 m0, s65, 97280
    s_add_u32 s34, s63, 3244032
    buffer_load_dwordx4 v75, s[40:43], s34 offen lds
    s_waitcnt vmcnt(18)
    s_barrier
    s_add_u32 m0, s64, 110592
    s_add_u32 s34, s59, 1792
    buffer_load_dwordx4 v65, s[16:19], s34 offen lds
    s_add_u32 m0, s64, 111616
    s_add_u32 s34, s59, 1792
    buffer_load_dwordx4 v66, s[16:19], s34 offen lds
    s_add_u32 m0, s64, 112640
    s_add_u32 s34, s59, 1792
    buffer_load_dwordx4 v67, s[16:19], s34 offen lds
    s_add_u32 m0, s64, 113664
    s_add_u32 s34, s59, 1792
    buffer_load_dwordx4 v68, s[16:19], s34 offen lds
    s_add_u32 m0, s64, 114688
    s_add_u32 s34, s59, 1792
    buffer_load_dwordx4 v69, s[16:19], s34 offen lds
    s_add_u32 m0, s65, 131072
    s_add_u32 s34, s63, 3670016
    buffer_load_dwordx4 v74, s[40:43], s34 offen lds
    s_add_u32 m0, s65, 132096
    s_add_u32 s34, s63, 3702784
    buffer_load_dwordx4 v75, s[40:43], s34 offen lds
    s_add_u32 m0, s65, 133120
    s_add_u32 s34, s63, 3735552
    buffer_load_dwordx4 v74, s[40:43], s34 offen lds
    s_add_u32 m0, s65, 134144
    s_add_u32 s34, s63, 3768320
    buffer_load_dwordx4 v75, s[40:43], s34 offen lds
    s_waitcnt vmcnt(18)
    s_barrier
    s_add_u32 m0, s64, 0
    s_add_u32 s34, s59, 2048
    buffer_load_dwordx4 v65, s[16:19], s34 offen lds
    s_add_u32 m0, s64, 1024
    s_add_u32 s34, s59, 2048
    buffer_load_dwordx4 v66, s[16:19], s34 offen lds
    s_add_u32 m0, s64, 2048
    s_add_u32 s34, s59, 2048
    buffer_load_dwordx4 v67, s[16:19], s34 offen lds
    s_add_u32 m0, s64, 3072
    s_add_u32 s34, s59, 2048
    buffer_load_dwordx4 v68, s[16:19], s34 offen lds
    s_add_u32 m0, s64, 4096
    s_add_u32 s34, s59, 2048
    buffer_load_dwordx4 v69, s[16:19], s34 offen lds
    s_add_u32 m0, s65, 20480
    s_add_u32 s34, s63, 4194304
    buffer_load_dwordx4 v74, s[40:43], s34 offen lds
    s_add_u32 m0, s65, 21504
    s_add_u32 s34, s63, 4227072
    buffer_load_dwordx4 v75, s[40:43], s34 offen lds
    s_add_u32 m0, s65, 22528
    s_add_u32 s34, s63, 4259840
    buffer_load_dwordx4 v74, s[40:43], s34 offen lds
    s_add_u32 m0, s65, 23552
    s_add_u32 s34, s63, 4292608
    buffer_load_dwordx4 v75, s[40:43], s34 offen lds
    s_waitcnt vmcnt(18)
    s_barrier
    s_add_u32 m0, s64, 36864
    s_add_u32 s34, s59, 2304
    buffer_load_dwordx4 v65, s[16:19], s34 offen lds
    s_add_u32 m0, s64, 37888
    s_add_u32 s34, s59, 2304
    buffer_load_dwordx4 v66, s[16:19], s34 offen lds
    s_add_u32 m0, s64, 38912
    s_add_u32 s34, s59, 2304
    buffer_load_dwordx4 v67, s[16:19], s34 offen lds
    s_add_u32 m0, s64, 39936
    s_add_u32 s34, s59, 2304
    buffer_load_dwordx4 v68, s[16:19], s34 offen lds
    s_add_u32 m0, s64, 40960
    s_add_u32 s34, s59, 2304
    buffer_load_dwordx4 v69, s[16:19], s34 offen lds
    s_add_u32 m0, s65, 57344
    s_add_u32 s34, s63, 4718592
    buffer_load_dwordx4 v74, s[40:43], s34 offen lds
    s_add_u32 m0, s65, 58368
    s_add_u32 s34, s63, 4751360
    buffer_load_dwordx4 v75, s[40:43], s34 offen lds
    s_add_u32 m0, s65, 59392
    s_add_u32 s34, s63, 4784128
    buffer_load_dwordx4 v74, s[40:43], s34 offen lds
    s_add_u32 m0, s65, 60416
    s_add_u32 s34, s63, 4816896
    buffer_load_dwordx4 v75, s[40:43], s34 offen lds
    s_waitcnt vmcnt(18)
    s_barrier
    s_add_u32 m0, s64, 73728
    s_add_u32 s34, s59, 2560
    buffer_load_dwordx4 v65, s[16:19], s34 offen lds
    s_add_u32 m0, s64, 74752
    s_add_u32 s34, s59, 2560
    buffer_load_dwordx4 v66, s[16:19], s34 offen lds
    s_add_u32 m0, s64, 75776
    s_add_u32 s34, s59, 2560
    buffer_load_dwordx4 v67, s[16:19], s34 offen lds
    s_add_u32 m0, s64, 76800
    s_add_u32 s34, s59, 2560
    buffer_load_dwordx4 v68, s[16:19], s34 offen lds
    s_add_u32 m0, s64, 77824
    s_add_u32 s34, s59, 2560
    buffer_load_dwordx4 v69, s[16:19], s34 offen lds
    s_add_u32 m0, s65, 94208
    s_add_u32 s34, s63, 5242880
    buffer_load_dwordx4 v74, s[40:43], s34 offen lds
    s_add_u32 m0, s65, 95232
    s_add_u32 s34, s63, 5275648
    buffer_load_dwordx4 v75, s[40:43], s34 offen lds
    s_add_u32 m0, s65, 96256
    s_add_u32 s34, s63, 5308416
    buffer_load_dwordx4 v74, s[40:43], s34 offen lds
    s_add_u32 m0, s65, 97280
    s_add_u32 s34, s63, 5341184
    buffer_load_dwordx4 v75, s[40:43], s34 offen lds
    s_waitcnt vmcnt(18)
    s_barrier
    s_add_u32 m0, s64, 110592
    s_add_u32 s34, s59, 2816
    buffer_load_dwordx4 v65, s[16:19], s34 offen lds
    s_add_u32 m0, s64, 111616
    s_add_u32 s34, s59, 2816
    buffer_load_dwordx4 v66, s[16:19], s34 offen lds
    s_add_u32 m0, s64, 112640
    s_add_u32 s34, s59, 2816
    buffer_load_dwordx4 v67, s[16:19], s34 offen lds
    s_add_u32 m0, s64, 113664
    s_add_u32 s34, s59, 2816
    buffer_load_dwordx4 v68, s[16:19], s34 offen lds
    s_add_u32 m0, s64, 114688
    s_add_u32 s34, s59, 2816
    buffer_load_dwordx4 v69, s[16:19], s34 offen lds
    s_add_u32 m0, s65, 131072
    s_add_u32 s34, s63, 5767168
    buffer_load_dwordx4 v74, s[40:43], s34 offen lds
    s_add_u32 m0, s65, 132096
    s_add_u32 s34, s63, 5799936
    buffer_load_dwordx4 v75, s[40:43], s34 offen lds
    s_add_u32 m0, s65, 133120
    s_add_u32 s34, s63, 5832704
    buffer_load_dwordx4 v74, s[40:43], s34 offen lds
    s_add_u32 m0, s65, 134144
    s_add_u32 s34, s63, 5865472
    buffer_load_dwordx4 v75, s[40:43], s34 offen lds
    s_waitcnt vmcnt(18)
    s_barrier
    s_add_u32 m0, s64, 0
    s_add_u32 s34, s58, 0
    buffer_load_dwordx4 v60, s[8:11], s34 offen lds
    s_add_u32 m0, s64, 1024
    s_add_u32 s34, s58, 0
    buffer_load_dwordx4 v61, s[8:11], s34 offen lds
    s_add_u32 m0, s64, 2048
    s_add_u32 s34, s58, 0
    buffer_load_dwordx4 v62, s[8:11], s34 offen lds
    s_add_u32 m0, s64, 3072
    s_add_u32 s34, s58, 0
    buffer_load_dwordx4 v63, s[8:11], s34 offen lds
    s_add_u32 m0, s64, 4096
    s_add_u32 s34, s58, 0
    buffer_load_dwordx4 v64, s[8:11], s34 offen lds
    s_add_u32 m0, s65, 20480
    s_add_u32 s34, s62, 0
    buffer_load_dwordx4 v70, s[12:15], s34 offen lds
    s_add_u32 m0, s65, 21504
    s_add_u32 s34, s62, 5120
    buffer_load_dwordx4 v71, s[12:15], s34 offen lds
    s_add_u32 m0, s65, 22528
    s_add_u32 s34, s62, 10240
    buffer_load_dwordx4 v72, s[12:15], s34 offen lds
    s_add_u32 m0, s65, 23552
    s_add_u32 s34, s62, 15360
    buffer_load_dwordx4 v73, s[12:15], s34 offen lds
    s_waitcnt vmcnt(18)
    s_barrier
    s_add_u32 m0, s64, 36864
    s_add_u32 s34, s58, 163840
    buffer_load_dwordx4 v60, s[8:11], s34 offen lds
    s_add_u32 m0, s64, 37888
    s_add_u32 s34, s58, 163840
    buffer_load_dwordx4 v61, s[8:11], s34 offen lds
    s_add_u32 m0, s64, 38912
    s_add_u32 s34, s58, 163840
    buffer_load_dwordx4 v62, s[8:11], s34 offen lds
    s_add_u32 m0, s64, 39936
    s_add_u32 s34, s58, 163840
    buffer_load_dwordx4 v63, s[8:11], s34 offen lds
    s_add_u32 m0, s64, 40960
    s_add_u32 s34, s58, 163840
    buffer_load_dwordx4 v64, s[8:11], s34 offen lds
    s_add_u32 m0, s65, 57344
    s_add_u32 s34, s62, 256
    buffer_load_dwordx4 v70, s[12:15], s34 offen lds
    s_add_u32 m0, s65, 58368
    s_add_u32 s34, s62, 5376
    buffer_load_dwordx4 v71, s[12:15], s34 offen lds
    s_add_u32 m0, s65, 59392
    s_add_u32 s34, s62, 10496
    buffer_load_dwordx4 v72, s[12:15], s34 offen lds
    s_add_u32 m0, s65, 60416
    s_add_u32 s34, s62, 15616
    buffer_load_dwordx4 v73, s[12:15], s34 offen lds
    s_waitcnt vmcnt(18)
    s_barrier
    s_add_u32 m0, s64, 73728
    s_add_u32 s34, s58, 327680
    buffer_load_dwordx4 v60, s[8:11], s34 offen lds
    s_add_u32 m0, s64, 74752
    s_add_u32 s34, s58, 327680
    buffer_load_dwordx4 v61, s[8:11], s34 offen lds
    s_add_u32 m0, s64, 75776
    s_add_u32 s34, s58, 327680
    buffer_load_dwordx4 v62, s[8:11], s34 offen lds
    s_add_u32 m0, s64, 76800
    s_add_u32 s34, s58, 327680
    buffer_load_dwordx4 v63, s[8:11], s34 offen lds
    s_add_u32 m0, s64, 77824
    s_add_u32 s34, s58, 327680
    buffer_load_dwordx4 v64, s[8:11], s34 offen lds
    s_add_u32 m0, s65, 94208
    s_add_u32 s34, s62, 512
    buffer_load_dwordx4 v70, s[12:15], s34 offen lds
    s_add_u32 m0, s65, 95232
    s_add_u32 s34, s62, 5632
    buffer_load_dwordx4 v71, s[12:15], s34 offen lds
    s_add_u32 m0, s65, 96256
    s_add_u32 s34, s62, 10752
    buffer_load_dwordx4 v72, s[12:15], s34 offen lds
    s_add_u32 m0, s65, 97280
    s_add_u32 s34, s62, 15872
    buffer_load_dwordx4 v73, s[12:15], s34 offen lds
    s_waitcnt vmcnt(18)
    s_barrier
    s_add_u32 m0, s64, 110592
    s_add_u32 s34, s58, 491520
    buffer_load_dwordx4 v60, s[8:11], s34 offen lds
    s_add_u32 m0, s64, 111616
    s_add_u32 s34, s58, 491520
    buffer_load_dwordx4 v61, s[8:11], s34 offen lds
    s_add_u32 m0, s64, 112640
    s_add_u32 s34, s58, 491520
    buffer_load_dwordx4 v62, s[8:11], s34 offen lds
    s_add_u32 m0, s64, 113664
    s_add_u32 s34, s58, 491520
    buffer_load_dwordx4 v63, s[8:11], s34 offen lds
    s_add_u32 m0, s64, 114688
    s_add_u32 s34, s58, 491520
    buffer_load_dwordx4 v64, s[8:11], s34 offen lds
    s_add_u32 m0, s65, 131072
    s_add_u32 s34, s62, 768
    buffer_load_dwordx4 v70, s[12:15], s34 offen lds
    s_add_u32 m0, s65, 132096
    s_add_u32 s34, s62, 5888
    buffer_load_dwordx4 v71, s[12:15], s34 offen lds
    s_add_u32 m0, s65, 133120
    s_add_u32 s34, s62, 11008
    buffer_load_dwordx4 v72, s[12:15], s34 offen lds
    s_add_u32 m0, s65, 134144
    s_add_u32 s34, s62, 16128
    buffer_load_dwordx4 v73, s[12:15], s34 offen lds
    s_waitcnt vmcnt(18)
    s_barrier
    s_add_u32 m0, s64, 0
    s_add_u32 s34, s58, 655360
    buffer_load_dwordx4 v60, s[8:11], s34 offen lds
    s_add_u32 m0, s64, 1024
    s_add_u32 s34, s58, 655360
    buffer_load_dwordx4 v61, s[8:11], s34 offen lds
    s_add_u32 m0, s64, 2048
    s_add_u32 s34, s58, 655360
    buffer_load_dwordx4 v62, s[8:11], s34 offen lds
    s_add_u32 m0, s64, 3072
    s_add_u32 s34, s58, 655360
    buffer_load_dwordx4 v63, s[8:11], s34 offen lds
    s_add_u32 m0, s64, 4096
    s_add_u32 s34, s58, 655360
    buffer_load_dwordx4 v64, s[8:11], s34 offen lds
    s_add_u32 m0, s65, 20480
    s_add_u32 s34, s62, 1024
    buffer_load_dwordx4 v70, s[12:15], s34 offen lds
    s_add_u32 m0, s65, 21504
    s_add_u32 s34, s62, 6144
    buffer_load_dwordx4 v71, s[12:15], s34 offen lds
    s_add_u32 m0, s65, 22528
    s_add_u32 s34, s62, 11264
    buffer_load_dwordx4 v72, s[12:15], s34 offen lds
    s_add_u32 m0, s65, 23552
    s_add_u32 s34, s62, 16384
    buffer_load_dwordx4 v73, s[12:15], s34 offen lds
    s_waitcnt vmcnt(18)
    s_barrier
    s_waitcnt vmcnt(9)
    s_barrier
    s_waitcnt vmcnt(0)
    s_barrier
    s_endpgm
K3_END:
    s_endpgm
TEXT_END:
.section .rodata,"a"
.p2align 6
.amdhsa_kernel k1_kernel
  .amdhsa_next_free_vgpr 144
  .amdhsa_next_free_sgpr 80
  .amdhsa_accum_offset 144
  .amdhsa_group_segment_fixed_size 0
  .amdhsa_kernarg_size 112
  .amdhsa_user_sgpr_count 2
  .amdhsa_user_sgpr_kernarg_segment_ptr 1
  .amdhsa_system_sgpr_workgroup_id_x 1
.end_amdhsa_kernel
.p2align 6
.amdhsa_kernel k2_kernel
  .amdhsa_next_free_vgpr 124
  .amdhsa_next_free_sgpr 84
  .amdhsa_accum_offset 124
  .amdhsa_group_segment_fixed_size 0
  .amdhsa_kernarg_size 112
  .amdhsa_user_sgpr_count 2
  .amdhsa_user_sgpr_kernarg_segment_ptr 1
  .amdhsa_system_sgpr_workgroup_id_x 1
.end_amdhsa_kernel
.p2align 6
.amdhsa_kernel k3_kernel
  .amdhsa_next_free_vgpr 136
  .amdhsa_next_free_sgpr 80
  .amdhsa_accum_offset 136
  .amdhsa_group_segment_fixed_size 0
  .amdhsa_kernarg_size 112
  .amdhsa_user_sgpr_count 2
  .amdhsa_user_sgpr_kernarg_segment_ptr 1
  .amdhsa_system_sgpr_workgroup_id_x 1
.end_amdhsa_kernel
```
